```python
import torch

def _softmax(x, axis=-1):
    return torch.softmax(x, dim=axis)
def _gelu(x):
    return torch.nn.functional.gelu(x, approximate="tanh")
def _silu(x):
    return torch.nn.functional.silu(x)
def _sigmoid(x):
    return torch.sigmoid(x)
def _layernorm(x, axis=-1, eps=1e-5):
    m = x.mean(dim=axis, keepdim=True)
    v = x.var(dim=axis, keepdim=True, unbiased=False)
    return (x - m) / torch.sqrt(v + eps)
def _scatter_add(tgt, idx, src, axis=0):
    return tgt.clone().index_add_(axis, idx, src)
def _segment_sum(src, seg, n):
    out = torch.zeros((n,) + src.shape[1:], dtype=src.dtype)
    return out.index_add_(0, seg, src)
def _pad(x, pw):
    flat = tuple(v for pair in reversed(pw) for v in pair)
    return torch.nn.functional.pad(x, flat)

kernel_name = 'standalone__normalfloat_lut_nf4__prompt'

def setup_inputs():

    _w = (lambda a: (lambda t: t.to(torch.bfloat16) if t.is_floating_point() else t)(torch.as_tensor(a)))
    B, S, D, F = 1, 2048, 576, 4608
    G = -1 if -1 > 0 else D
    D = (D // G) * G
    ng = D // G
    qw = torch.randint(0, 16, (D, F)).to(torch.int64)
    return {
        "x": _w((lambda *s: torch.randn(*s, dtype=torch.bfloat16) * 0.05)(B, S, D)),
        "qw": _w(qw),
        "absmax": _w(torch.abs((lambda *s: torch.randn(*s, dtype=torch.bfloat16) * 0.05)(ng, F)).to(float) + 0.01),
    }

def reference(x, qw, absmax):
    NF4 = torch.as_tensor([
        -1.0, -0.6961928009986877, -0.5250730514526367, -0.39491748809814453,
        -0.28444138169288635, -0.18477343022823334, -0.09105003625154495, 0.0,
        0.07958029955625534, 0.16093020141124725, 0.24611230194568634,
        0.33791524171829224, 0.44070982933044434, 0.5626170039176941,
        0.7229568362236023, 1.0,
    ])
    D, F = qw.shape[0], qw.shape[1]
    ng = absmax.shape[0]
    G = D // ng
    w = (lambda x, dt: x.to(dt))(NF4[qw], x.dtype)
    s = (lambda x, n, axis: torch.repeat_interleave(x, n, dim=axis))(absmax, G, axis=0)
    w = w * s
    return torch.einsum("bsd,df->bsf", x, w)
```

```asm
; @launch grid=(256,1,1) block=(512,1,1) lds=163840
.amdgcn_target "amdgcn-amd-amdhsa--gfx950"
.text
.globl standalone__normalfloat_lut_nf4__prompt_kernel
.p2align 12
.p2align 8
.type standalone__normalfloat_lut_nf4__prompt_kernel,@function
standalone__normalfloat_lut_nf4__prompt_kernel:
    s_load_dwordx4 s[20:23], s[0:1], 0
    s_load_dwordx4 s[24:27], s[0:1], 16
    v_lshrrev_b32 v1, 6, v0
    s_and_b32 s33, s2, 7
    v_readfirstlane_b32 s3, v1
    s_lshr_b32 s34, s2, 3
    s_and_b32 s35, s34, 3
    s_lshl_b32 s28, s33, 2
    s_add_u32 s28, s28, s35
    s_lshr_b32 s29, s34, 2
    s_lshr_b32 s36, s33, 1
    s_add_u32 s36, s36, 32
    s_and_b32 s37, s33, 1
    s_lshl_b32 s37, s37, 2
    s_add_u32 s37, s37, s35
    s_cmp_ge_u32 s34, 28
    s_cselect_b32 s28, s36, s28
    s_cselect_b32 s29, s37, s29
    s_cselect_b32 s35, 4, s35
    s_mul_i32 s67, s35, 0
    s_mul_i32 s39, s33, 5
    s_add_u32 s67, s67, s39
    s_cmp_ge_u32 s2, 256
    s_cselect_b32 s29, 7, s29
    s_cmp_ge_u32 s29, 7
    s_cbranch_scc1 L_exit
    s_mul_i32 s30, s29, 288
    s_lshl_b32 s36, s29, 2
    s_lshr_b32 s36, 0x2221110, s36
    s_and_b32 s36, s36, 15
    s_lshl4_add_u32 s30, s36, s30
    s_lshr_b32 s99, 9, s29
    s_and_b32 s99, s99, 1
    s_mul_i32 s32, s29, 3
    s_lshl_b32 s36, s35, 2
    s_lshr_b32 s36, 0x3300, s36
    s_and_b32 s36, s36, 15
    s_add_u32 s32, s32, s36
    s_mul_i32 s36, s33, 1
    s_add_u32 s32, s32, s36
    s_mul_i32 s36, s32, 57
    s_lshr_b32 s36, s36, 9
    s_mul_i32 s36, s36, 9
    s_sub_u32 s32, s32, s36
    s_lshl_b32 s40, s32, 7
    v_and_b32 v0, 63, v0
    s_mov_b32 s6, 2359296
    s_mov_b32 s7, 0x20000
    s_mov_b32 s10, 10616832
    s_mov_b32 s11, 0x20000
    s_mov_b32 s14, 18874368
    s_mov_b32 s15, 0x20000
    s_mov_b32 s18, 9216
    s_mov_b32 s19, 0x20000
    s_mov_b64 vcc, 0
    s_xor_b32 s3, s3, 4
    s_cmp_lt_u32 s3, 4
    s_cbranch_scc1 L_consumer
    s_sub_u32 s33, s3, 4
    v_and_b32 v9, 31, v0
    v_lshrrev_b32 v10, 5, v0
    s_lshl_b32 s34, s33, 1
    v_add_u32 v10, s34, v10
    s_mov_b32 s35, 147456
    v_mul_lo_u32 v1, v10, s35
    v_lshl_add_u32 v1, v9, 4, v1
    s_lshl_b32 s34, s28, 9
    v_add_u32 v1, s34, v1
    s_mov_b32 s60, 18432
    s_mov_b32 s61, 36864
    s_mov_b32 s62, 55296
    s_mov_b32 s63, 73728
    s_mov_b32 s64, 92160
    s_mov_b32 s65, 110592
    s_mov_b32 s66, 129024
    s_waitcnt lgkmcnt(0)
    s_mov_b32 s8, s22
    s_mov_b32 s9, s23
    s_mul_i32 s49, s40, 9216
    v_add_u32 v2, s49, v1
    buffer_load_dwordx4 v[32:35], v2, s[8:11], 0 offen
    buffer_load_dwordx4 v[36:39], v2, s[8:11], s60 offen
    buffer_load_dwordx4 v[40:43], v2, s[8:11], s61 offen
    buffer_load_dwordx4 v[44:47], v2, s[8:11], s62 offen
    buffer_load_dwordx4 v[48:51], v2, s[8:11], s63 offen
    buffer_load_dwordx4 v[52:55], v2, s[8:11], s64 offen
    buffer_load_dwordx4 v[56:59], v2, s[8:11], s65 offen
    buffer_load_dwordx4 v[60:63], v2, s[8:11], s66 offen
    s_branch L_h2
L_exit:
    s_endpgm
L_consumer:
    s_setprio 1
    v_and_b32 v20, 15, v0
    v_lshrrev_b32 v21, 4, v0
    s_lshl_b32 s34, s28, 8
    s_lshl_b32 s35, s3, 6
    s_add_u32 s34, s34, s35
    v_lshlrev_b32 v22, 2, v20
    s_waitcnt lgkmcnt(0)
    s_mov_b32 s16, s24
    s_mov_b32 s17, s25
    s_mov_b32 s4, s20
    s_mov_b32 s5, s21
    s_mov_b32 s8, s22
    s_mov_b32 s9, s23
    s_mov_b32 s12, s26
    s_mov_b32 s13, s27
    buffer_load_dword v200, v22, s[16:19], s34 offen
    v_lshrrev_b32 v23, 1, v20
    v_xor_b32 v1, v21, v23
    v_lshlrev_b32 v1, 4, v1
    v_lshl_add_u32 v1, v20, 7, v1
    v_xor_b32 v2, 64, v1
    s_lshl_b32 s35, s3, 3
    v_add_u32 v23, s35, v23
    v_and_b32 v24, 1, v20
    v_mul_u32_u24 v24, 40, v24
    v_xor_b32 v23, v23, v24
    v_lshlrev_b32 v23, 4, v23
    v_lshl_add_u32 v23, v21, 10, v23
    v_add_u32 v3, 147456, v23
    v_lshl_add_u32 v23, v21, 2, s30
    s_mov_b32 s62, 9216
    v_mul_lo_u32 v23, v23, s62
    v_lshl_add_u32 v23, v20, 2, v23
    v_add_u32 v0, s34, v23
    s_mov_b32 s63, s67
    v_mov_b32 v8, 0
    s_mov_b32 s52, 0x06040200
    s_mov_b32 s53, 0x07050301
    s_mov_b32 s54, 0x0b0a0908
    s_mov_b32 s55, 0xffffff00
    s_mov_b32 s56, 0x05010400
    s_mov_b32 s57, 0x07030602
    s_mov_b32 s58, 0x08080808
    s_mov_b32 s59, 0x10000
    s_mov_b32 s51, 0xffff0000
    s_mov_b32 s39, 0
L_warm:
    s_lshr_b32 s34, s2, 3
    s_lshl2_add_u32 s34, s3, s34
    s_mul_i32 s36, s34, 4370
    s_lshr_b32 s36, s36, 16
    s_mul_i32 s36, s36, 15
    s_sub_u32 s34, s34, s36
    s_add_u32 s34, s34, 7
    s_add_u32 s36, s3, 4
    s_cmp_lt_u32 s36, 7
    s_cselect_b32 s36, s36, s34
    s_cmp_lt_u32 s3, 7
    s_cselect_b32 s37, s3, s34
    s_mov_b32 s38, 2
    s_mov_b64 vcc, -1
L_tret:
    s_cmp_eq_u32 s38, 0
    s_cbranch_scc1 L_tdone
    s_sub_u32 s38, s38, 1
    s_getpc_b64 s[76:77]
L_tpc:
    s_lshl2_add_u32 s76, s37, s76
    s_addc_u32 s77, s77, 0
    s_add_u32 s76, s76, 28
    s_addc_u32 s77, s77, 0
    s_mov_b32 s37, s36
    s_mov_b32 s36, s34
    s_setpc_b64 s[76:77]
L_ttab:
    s_branch L_cmain
    s_branch L_t8
    s_branch L_t4
    s_branch L_t12
    s_branch L_t16
    s_branch L_t20
    s_branch L_c18
    s_branch L_t5
    s_branch L_t6
    s_branch L_t7
    s_branch L_t9
    s_branch L_t10
    s_branch L_t11
    s_branch L_t13
    s_branch L_t14
    s_branch L_t15
    s_branch L_t17
    s_branch L_t18
    s_branch L_t19
    s_branch L_t21
    s_branch L_t22
    s_branch L_t23
    s_branch L_tret
    s_branch L_tret
L_tdone:
    s_mov_b64 vcc, 0
    s_branch L_cmain
L_h2:
    s_add_u32 s41, s40, 128
    s_cmp_eq_u32 s41, 1152
    s_cselect_b32 s41, 0, s41
    s_add_u32 s42, s41, 128
    s_cmp_eq_u32 s42, 1152
    s_cselect_b32 s42, 0, s42
    s_add_u32 s43, s42, 128
    s_cmp_eq_u32 s43, 1152
    s_cselect_b32 s43, 0, s43
    s_add_u32 s44, s43, 128
    s_cmp_eq_u32 s44, 1152
    s_cselect_b32 s44, 0, s44
    s_add_u32 s45, s44, 128
    s_cmp_eq_u32 s45, 1152
    s_cselect_b32 s45, 0, s45
    s_add_u32 s46, s45, 128
    s_cmp_eq_u32 s46, 1152
    s_cselect_b32 s46, 0, s46
    s_add_u32 s47, s46, 128
    s_cmp_eq_u32 s47, 1152
    s_cselect_b32 s47, 0, s47
    s_add_u32 s48, s47, 128
    s_cmp_eq_u32 s48, 1152
    s_cselect_b32 s48, 0, s48
    s_mov_b32 s4, s20
    s_mov_b32 s5, s21
    s_mov_b32 s12, s26
    s_mov_b32 s13, s27
    s_cmp_eq_u32 s99, 0
    s_cselect_b32 s39, 18, 19
    s_lshr_b32 s34, s33, 1
    s_add_u32 s38, s67, s34
    s_cmp_ge_u32 s38, s39
    s_cselect_b32 s34, s39, 0
    s_sub_u32 s38, s38, s34
    s_cmp_ge_u32 s38, s39
    s_cselect_b32 s34, s39, 0
    s_sub_u32 s38, s38, s34
    s_mul_i32 s80, s38, 18432
    s_mul_i32 s39, s39, 18432
    s_mov_b32 s50, 36864
    s_add_u32 s81, s80, s50
    s_cmp_ge_u32 s81, s39
    s_cselect_b32 s34, s39, 0
    s_sub_u32 s81, s81, s34
    s_add_u32 s82, s81, s50
    s_cmp_ge_u32 s82, s39
    s_cselect_b32 s34, s39, 0
    s_sub_u32 s82, s82, s34
    s_add_u32 s83, s82, s50
    s_cmp_ge_u32 s83, s39
    s_cselect_b32 s34, s39, 0
    s_sub_u32 s83, s83, s34
    s_add_u32 s84, s83, s50
    s_cmp_ge_u32 s84, s39
    s_cselect_b32 s34, s39, 0
    s_sub_u32 s84, s84, s34
    s_add_u32 s85, s84, s50
    s_cmp_ge_u32 s85, s39
    s_cselect_b32 s34, s39, 0
    s_sub_u32 s85, s85, s34
    s_add_u32 s86, s85, s50
    s_cmp_ge_u32 s86, s39
    s_cselect_b32 s34, s39, 0
    s_sub_u32 s86, s86, s34
    s_add_u32 s87, s86, s50
    s_cmp_ge_u32 s87, s39
    s_cselect_b32 s34, s39, 0
    s_sub_u32 s87, s87, s34
    s_add_u32 s88, s87, s50
    s_cmp_ge_u32 s88, s39
    s_cselect_b32 s34, s39, 0
    s_sub_u32 s88, s88, s34
    s_add_u32 s89, s88, s50
    s_cmp_ge_u32 s89, s39
    s_cselect_b32 s34, s39, 0
    s_sub_u32 s89, s89, s34
    v_lshlrev_b32 v6, 10, v10
    v_add_u32 v6, 147456, v6
    v_xor_b32 v7, 8, v9
    v_lshl_add_u32 v7, v7, 4, v6
    v_add_u32 v7, 512, v7
    v_lshl_add_u32 v6, v9, 4, v6
    v_lshrrev_b32 v9, 3, v0
    v_add_u32 v9, s30, v9
    v_mul_u32_u24 v9, 1152, v9
    v_lshrrev_b32 v10, 4, v0
    v_and_b32 v8, 7, v0
    v_xor_b32 v10, v8, v10
    v_lshl_add_u32 v4, v10, 4, v9
    v_xor_b32 v5, 64, v4
    s_and_b32 s35, s33, 1
    s_lshl_b32 s34, s35, 6
    v_xor_b32 v3, s34, v4
    s_mul_i32 s34, s35, 9216
    v_add_u32 v3, s34, v3
    s_lshl_b32 s68, s33, 10
    s_mul_i32 s49, s41, 9216
    v_add_u32 v2, s49, v1
    buffer_load_dwordx4 v[64:67], v2, s[8:11], 0 offen
    buffer_load_dwordx4 v[68:71], v2, s[8:11], s60 offen
    s_waitcnt vmcnt(6)
    buffer_load_dwordx4 v[72:75], v2, s[8:11], s61 offen
    v_lshl_or_b32 v32, v36, 8, v32
    v_lshl_or_b32 v40, v44, 8, v40
    v_lshl_or_b32 v16, v40, 16, v32
    v_lshl_or_b32 v33, v37, 8, v33
    v_lshl_or_b32 v41, v45, 8, v41
    v_lshl_or_b32 v18, v41, 16, v33
    buffer_load_dwordx4 v[76:79], v2, s[8:11], s62 offen
    v_lshl_or_b32 v34, v38, 8, v34
    v_lshl_or_b32 v42, v46, 8, v42
    v_lshl_or_b32 v20, v42, 16, v34
    v_lshl_or_b32 v35, v39, 8, v35
    v_lshl_or_b32 v43, v47, 8, v43
    v_lshl_or_b32 v22, v43, 16, v35
    s_waitcnt vmcnt(4)
    s_nop 0
    buffer_load_dwordx4 v[80:83], v2, s[8:11], s63 offen
    v_lshl_or_b32 v48, v52, 8, v48
    v_lshl_or_b32 v56, v60, 8, v56
    v_lshl_or_b32 v17, v56, 16, v48
    v_lshl_or_b32 v49, v53, 8, v49
    v_lshl_or_b32 v57, v61, 8, v57
    v_lshl_or_b32 v19, v57, 16, v49
    ds_write_b128 v6, v[16:19] offset:0
    buffer_load_dwordx4 v[84:87], v2, s[8:11], s64 offen
    v_lshl_or_b32 v50, v54, 8, v50
    v_lshl_or_b32 v58, v62, 8, v58
    v_lshl_or_b32 v21, v58, 16, v50
    v_lshl_or_b32 v51, v55, 8, v51
    v_lshl_or_b32 v59, v63, 8, v59
    v_lshl_or_b32 v23, v59, 16, v51
    ds_write_b128 v7, v[20:23] offset:0
    buffer_load_dwordx4 v[88:91], v2, s[8:11], s65 offen
    buffer_load_dwordx4 v[92:95], v2, s[8:11], s66 offen
    s_waitcnt lgkmcnt(0)
    s_barrier
    s_add_u32 m0, s68, 0
    s_add_u32 s49, s40, s80
    buffer_load_dwordx4 v3, s[4:7], s49 offen lds
    s_add_u32 m0, s68, 4096
    s_add_u32 s49, s40, s81
    buffer_load_dwordx4 v3, s[4:7], s49 offen lds
    s_add_u32 m0, s68, 8192
    s_add_u32 s49, s40, s82
    buffer_load_dwordx4 v3, s[4:7], s49 offen lds
    s_add_u32 m0, s68, 12288
    s_add_u32 s49, s40, s83
    buffer_load_dwordx4 v3, s[4:7], s49 offen lds
    s_mul_i32 s49, s42, 9216
    v_add_u32 v2, s49, v1
    buffer_load_dwordx4 v[32:35], v2, s[8:11], 0 offen
    buffer_load_dwordx4 v[36:39], v2, s[8:11], s60 offen
    s_waitcnt vmcnt(10)
    s_nop 0
    buffer_load_dwordx4 v[40:43], v2, s[8:11], s61 offen
    v_lshl_or_b32 v64, v68, 8, v64
    v_lshl_or_b32 v72, v76, 8, v72
    v_lshl_or_b32 v16, v72, 16, v64
    v_lshl_or_b32 v65, v69, 8, v65
    v_lshl_or_b32 v73, v77, 8, v73
    v_lshl_or_b32 v18, v73, 16, v65
    buffer_load_dwordx4 v[44:47], v2, s[8:11], s62 offen
    v_lshl_or_b32 v66, v70, 8, v66
    v_lshl_or_b32 v74, v78, 8, v74
    v_lshl_or_b32 v20, v74, 16, v66
    v_lshl_or_b32 v67, v71, 8, v67
    v_lshl_or_b32 v75, v79, 8, v75
    v_lshl_or_b32 v22, v75, 16, v67
    s_waitcnt vmcnt(8)
    s_nop 0
    buffer_load_dwordx4 v[48:51], v2, s[8:11], s63 offen
    v_lshl_or_b32 v80, v84, 8, v80
    v_lshl_or_b32 v88, v92, 8, v88
    v_lshl_or_b32 v17, v88, 16, v80
    v_lshl_or_b32 v81, v85, 8, v81
    v_lshl_or_b32 v89, v93, 8, v89
    v_lshl_or_b32 v19, v89, 16, v81
    ds_write_b128 v6, v[16:19] offset:8192
    buffer_load_dwordx4 v[52:55], v2, s[8:11], s64 offen
    v_lshl_or_b32 v82, v86, 8, v82
    v_lshl_or_b32 v90, v94, 8, v90
    v_lshl_or_b32 v21, v90, 16, v82
    v_lshl_or_b32 v83, v87, 8, v83
    v_lshl_or_b32 v91, v95, 8, v91
    v_lshl_or_b32 v23, v91, 16, v83
    ds_write_b128 v7, v[20:23] offset:8192
    buffer_load_dwordx4 v[56:59], v2, s[8:11], s65 offen
    buffer_load_dwordx4 v[60:63], v2, s[8:11], s66 offen
    s_waitcnt vmcnt(8) lgkmcnt(0)
    s_barrier
    s_add_u32 m0, s68, 16384
    s_add_u32 s49, s41, s80
    buffer_load_dwordx4 v3, s[4:7], s49 offen lds
    s_add_u32 m0, s68, 20480
    s_add_u32 s49, s41, s81
    buffer_load_dwordx4 v3, s[4:7], s49 offen lds
    s_add_u32 m0, s68, 24576
    s_add_u32 s49, s41, s82
    buffer_load_dwordx4 v3, s[4:7], s49 offen lds
    s_add_u32 m0, s68, 28672
    s_add_u32 s49, s41, s83
    buffer_load_dwordx4 v3, s[4:7], s49 offen lds
    s_mul_i32 s49, s43, 9216
    v_add_u32 v2, s49, v1
    buffer_load_dwordx4 v[64:67], v2, s[8:11], 0 offen
    buffer_load_dwordx4 v[68:71], v2, s[8:11], s60 offen
    s_waitcnt vmcnt(10)
    buffer_load_dwordx4 v[72:75], v2, s[8:11], s61 offen
    v_lshl_or_b32 v32, v36, 8, v32
    v_lshl_or_b32 v40, v44, 8, v40
    v_lshl_or_b32 v16, v40, 16, v32
    v_lshl_or_b32 v33, v37, 8, v33
    v_lshl_or_b32 v41, v45, 8, v41
    v_lshl_or_b32 v18, v41, 16, v33
    buffer_load_dwordx4 v[76:79], v2, s[8:11], s62 offen
    v_lshl_or_b32 v34, v38, 8, v34
    v_lshl_or_b32 v42, v46, 8, v42
    v_lshl_or_b32 v20, v42, 16, v34
    v_lshl_or_b32 v35, v39, 8, v35
    v_lshl_or_b32 v43, v47, 8, v43
    v_lshl_or_b32 v22, v43, 16, v35
    s_waitcnt vmcnt(8)
    s_nop 0
    buffer_load_dwordx4 v[80:83], v2, s[8:11], s63 offen
    v_lshl_or_b32 v48, v52, 8, v48
    v_lshl_or_b32 v56, v60, 8, v56
    v_lshl_or_b32 v17, v56, 16, v48
    v_lshl_or_b32 v49, v53, 8, v49
    v_lshl_or_b32 v57, v61, 8, v57
    v_lshl_or_b32 v19, v57, 16, v49
    ds_write_b128 v6, v[16:19] offset:0
    buffer_load_dwordx4 v[84:87], v2, s[8:11], s64 offen
    v_lshl_or_b32 v50, v54, 8, v50
    v_lshl_or_b32 v58, v62, 8, v58
    v_lshl_or_b32 v21, v58, 16, v50
    v_lshl_or_b32 v51, v55, 8, v51
    v_lshl_or_b32 v59, v63, 8, v59
    v_lshl_or_b32 v23, v59, 16, v51
    ds_write_b128 v7, v[20:23] offset:0
    buffer_load_dwordx4 v[88:91], v2, s[8:11], s65 offen
    buffer_load_dwordx4 v[92:95], v2, s[8:11], s66 offen
    s_waitcnt vmcnt(8) lgkmcnt(0)
    s_barrier
    s_add_u32 m0, s68, 32768
    s_add_u32 s49, s42, s80
    buffer_load_dwordx4 v3, s[4:7], s49 offen lds
    s_add_u32 m0, s68, 36864
    s_add_u32 s49, s42, s81
    buffer_load_dwordx4 v3, s[4:7], s49 offen lds
    s_add_u32 m0, s68, 40960
    s_add_u32 s49, s42, s82
    buffer_load_dwordx4 v3, s[4:7], s49 offen lds
    s_add_u32 m0, s68, 45056
    s_add_u32 s49, s42, s83
    buffer_load_dwordx4 v3, s[4:7], s49 offen lds
    s_mul_i32 s49, s44, 9216
    v_add_u32 v2, s49, v1
    buffer_load_dwordx4 v[32:35], v2, s[8:11], 0 offen
    buffer_load_dwordx4 v[36:39], v2, s[8:11], s60 offen
    s_waitcnt vmcnt(10)
    buffer_load_dwordx4 v[40:43], v2, s[8:11], s61 offen
    v_lshl_or_b32 v64, v68, 8, v64
    v_lshl_or_b32 v72, v76, 8, v72
    v_lshl_or_b32 v16, v72, 16, v64
    v_lshl_or_b32 v65, v69, 8, v65
    v_lshl_or_b32 v73, v77, 8, v73
    v_lshl_or_b32 v18, v73, 16, v65
    buffer_load_dwordx4 v[44:47], v2, s[8:11], s62 offen
    v_lshl_or_b32 v66, v70, 8, v66
    v_lshl_or_b32 v74, v78, 8, v74
    v_lshl_or_b32 v20, v74, 16, v66
    v_lshl_or_b32 v67, v71, 8, v67
    v_lshl_or_b32 v75, v79, 8, v75
    v_lshl_or_b32 v22, v75, 16, v67
    s_waitcnt vmcnt(8)
    s_nop 0
    buffer_load_dwordx4 v[48:51], v2, s[8:11], s63 offen
    v_lshl_or_b32 v80, v84, 8, v80
    v_lshl_or_b32 v88, v92, 8, v88
    v_lshl_or_b32 v17, v88, 16, v80
    v_lshl_or_b32 v81, v85, 8, v81
    v_lshl_or_b32 v89, v93, 8, v89
    v_lshl_or_b32 v19, v89, 16, v81
    ds_write_b128 v6, v[16:19] offset:8192
    buffer_load_dwordx4 v[52:55], v2, s[8:11], s64 offen
    v_lshl_or_b32 v82, v86, 8, v82
    v_lshl_or_b32 v90, v94, 8, v90
    v_lshl_or_b32 v21, v90, 16, v82
    v_lshl_or_b32 v83, v87, 8, v83
    v_lshl_or_b32 v91, v95, 8, v91
    v_lshl_or_b32 v23, v91, 16, v83
    ds_write_b128 v7, v[20:23] offset:8192
    buffer_load_dwordx4 v[56:59], v2, s[8:11], s65 offen
    buffer_load_dwordx4 v[60:63], v2, s[8:11], s66 offen
    s_waitcnt vmcnt(8) lgkmcnt(0)
    s_barrier
    s_add_u32 m0, s68, 49152
    s_add_u32 s49, s43, s80
    buffer_load_dwordx4 v3, s[4:7], s49 offen lds
    s_add_u32 m0, s68, 53248
    s_add_u32 s49, s43, s81
    buffer_load_dwordx4 v3, s[4:7], s49 offen lds
    s_add_u32 m0, s68, 57344
    s_add_u32 s49, s43, s82
    buffer_load_dwordx4 v3, s[4:7], s49 offen lds
    s_add_u32 m0, s68, 61440
    s_add_u32 s49, s43, s83
    buffer_load_dwordx4 v3, s[4:7], s49 offen lds
    s_mul_i32 s49, s45, 9216
    v_add_u32 v2, s49, v1
    buffer_load_dwordx4 v[64:67], v2, s[8:11], 0 offen
    buffer_load_dwordx4 v[68:71], v2, s[8:11], s60 offen
    s_waitcnt vmcnt(10)
    buffer_load_dwordx4 v[72:75], v2, s[8:11], s61 offen
    v_lshl_or_b32 v32, v36, 8, v32
    v_lshl_or_b32 v40, v44, 8, v40
    v_lshl_or_b32 v16, v40, 16, v32
    v_lshl_or_b32 v33, v37, 8, v33
    v_lshl_or_b32 v41, v45, 8, v41
    v_lshl_or_b32 v18, v41, 16, v33
    buffer_load_dwordx4 v[76:79], v2, s[8:11], s62 offen
    v_lshl_or_b32 v34, v38, 8, v34
    v_lshl_or_b32 v42, v46, 8, v42
    v_lshl_or_b32 v20, v42, 16, v34
    v_lshl_or_b32 v35, v39, 8, v35
    v_lshl_or_b32 v43, v47, 8, v43
    v_lshl_or_b32 v22, v43, 16, v35
    s_waitcnt vmcnt(8)
    s_nop 0
    buffer_load_dwordx4 v[80:83], v2, s[8:11], s63 offen
    v_lshl_or_b32 v48, v52, 8, v48
    v_lshl_or_b32 v56, v60, 8, v56
    v_lshl_or_b32 v17, v56, 16, v48
    v_lshl_or_b32 v49, v53, 8, v49
    v_lshl_or_b32 v57, v61, 8, v57
    v_lshl_or_b32 v19, v57, 16, v49
    ds_write_b128 v6, v[16:19] offset:0
    buffer_load_dwordx4 v[84:87], v2, s[8:11], s64 offen
    v_lshl_or_b32 v50, v54, 8, v50
    v_lshl_or_b32 v58, v62, 8, v58
    v_lshl_or_b32 v21, v58, 16, v50
    v_lshl_or_b32 v51, v55, 8, v51
    v_lshl_or_b32 v59, v63, 8, v59
    v_lshl_or_b32 v23, v59, 16, v51
    ds_write_b128 v7, v[20:23] offset:0
    buffer_load_dwordx4 v[88:91], v2, s[8:11], s65 offen
    buffer_load_dwordx4 v[92:95], v2, s[8:11], s66 offen
    s_waitcnt vmcnt(8) lgkmcnt(0)
    s_barrier
    s_add_u32 m0, s68, 65536
    s_add_u32 s49, s44, s80
    buffer_load_dwordx4 v3, s[4:7], s49 offen lds
    s_add_u32 m0, s68, 69632
    s_add_u32 s49, s44, s81
    buffer_load_dwordx4 v3, s[4:7], s49 offen lds
L_t4:
    s_cbranch_vccnz L_tret
    s_add_u32 m0, s68, 73728
    s_add_u32 s49, s44, s82
    buffer_load_dwordx4 v3, s[4:7], s49 offen lds
    s_add_u32 m0, s68, 77824
    s_add_u32 s49, s44, s83
    buffer_load_dwordx4 v3, s[4:7], s49 offen lds
    s_mul_i32 s49, s46, 9216
    v_add_u32 v2, s49, v1
    buffer_load_dwordx4 v[32:35], v2, s[8:11], 0 offen
    buffer_load_dwordx4 v[36:39], v2, s[8:11], s60 offen
    s_waitcnt vmcnt(10)
    s_nop 0
    buffer_load_dwordx4 v[40:43], v2, s[8:11], s61 offen
    v_lshl_or_b32 v64, v68, 8, v64
    v_lshl_or_b32 v72, v76, 8, v72
    v_lshl_or_b32 v16, v72, 16, v64
    v_lshl_or_b32 v65, v69, 8, v65
    v_lshl_or_b32 v73, v77, 8, v73
    v_lshl_or_b32 v18, v73, 16, v65
    buffer_load_dwordx4 v[44:47], v2, s[8:11], s62 offen
    v_lshl_or_b32 v66, v70, 8, v66
    v_lshl_or_b32 v74, v78, 8, v74
    v_lshl_or_b32 v20, v74, 16, v66
    v_lshl_or_b32 v67, v71, 8, v67
    v_lshl_or_b32 v75, v79, 8, v75
    v_lshl_or_b32 v22, v75, 16, v67
    s_waitcnt vmcnt(8)
    s_nop 0
    buffer_load_dwordx4 v[48:51], v2, s[8:11], s63 offen
    v_lshl_or_b32 v80, v84, 8, v80
    v_lshl_or_b32 v88, v92, 8, v88
    v_lshl_or_b32 v17, v88, 16, v80
    v_lshl_or_b32 v81, v85, 8, v81
    v_lshl_or_b32 v89, v93, 8, v89
    v_lshl_or_b32 v19, v89, 16, v81
    ds_write_b128 v6, v[16:19] offset:8192
    buffer_load_dwordx4 v[52:55], v2, s[8:11], s64 offen
    v_lshl_or_b32 v82, v86, 8, v82
    v_lshl_or_b32 v90, v94, 8, v90
    v_lshl_or_b32 v21, v90, 16, v82
    v_lshl_or_b32 v83, v87, 8, v83
    v_lshl_or_b32 v91, v95, 8, v91
    v_lshl_or_b32 v23, v91, 16, v83
    ds_write_b128 v7, v[20:23] offset:8192
    buffer_load_dwordx4 v[56:59], v2, s[8:11], s65 offen
    buffer_load_dwordx4 v[60:63], v2, s[8:11], s66 offen
    s_waitcnt vmcnt(8) lgkmcnt(0)
    s_barrier
    s_add_u32 m0, s68, 81920
    s_add_u32 s49, s45, s80
    buffer_load_dwordx4 v3, s[4:7], s49 offen lds
    s_add_u32 m0, s68, 86016
    s_add_u32 s49, s45, s81
    buffer_load_dwordx4 v3, s[4:7], s49 offen lds
    s_add_u32 m0, s68, 90112
    s_add_u32 s49, s45, s82
    buffer_load_dwordx4 v3, s[4:7], s49 offen lds
    s_add_u32 m0, s68, 94208
    s_add_u32 s49, s45, s83
    buffer_load_dwordx4 v3, s[4:7], s49 offen lds
    s_mul_i32 s49, s47, 9216
    v_add_u32 v2, s49, v1
    buffer_load_dwordx4 v[64:67], v2, s[8:11], 0 offen
    buffer_load_dwordx4 v[68:71], v2, s[8:11], s60 offen
    s_waitcnt vmcnt(10)
    buffer_load_dwordx4 v[72:75], v2, s[8:11], s61 offen
    v_lshl_or_b32 v32, v36, 8, v32
    v_lshl_or_b32 v40, v44, 8, v40
    v_lshl_or_b32 v16, v40, 16, v32
    v_lshl_or_b32 v33, v37, 8, v33
    v_lshl_or_b32 v41, v45, 8, v41
    v_lshl_or_b32 v18, v41, 16, v33
    buffer_load_dwordx4 v[76:79], v2, s[8:11], s62 offen
    v_lshl_or_b32 v34, v38, 8, v34
    v_lshl_or_b32 v42, v46, 8, v42
    v_lshl_or_b32 v20, v42, 16, v34
    v_lshl_or_b32 v35, v39, 8, v35
    v_lshl_or_b32 v43, v47, 8, v43
    v_lshl_or_b32 v22, v43, 16, v35
    s_waitcnt vmcnt(8)
    s_nop 0
    buffer_load_dwordx4 v[80:83], v2, s[8:11], s63 offen
    v_lshl_or_b32 v48, v52, 8, v48
    v_lshl_or_b32 v56, v60, 8, v56
    v_lshl_or_b32 v17, v56, 16, v48
    v_lshl_or_b32 v49, v53, 8, v49
    v_lshl_or_b32 v57, v61, 8, v57
    v_lshl_or_b32 v19, v57, 16, v49
    ds_write_b128 v6, v[16:19] offset:0
    buffer_load_dwordx4 v[84:87], v2, s[8:11], s64 offen
    v_lshl_or_b32 v50, v54, 8, v50
    v_lshl_or_b32 v58, v62, 8, v58
    v_lshl_or_b32 v21, v58, 16, v50
    v_lshl_or_b32 v51, v55, 8, v51
    v_lshl_or_b32 v59, v63, 8, v59
    v_lshl_or_b32 v23, v59, 16, v51
    ds_write_b128 v7, v[20:23] offset:0
    buffer_load_dwordx4 v[88:91], v2, s[8:11], s65 offen
    buffer_load_dwordx4 v[92:95], v2, s[8:11], s66 offen
    s_waitcnt vmcnt(8) lgkmcnt(0)
    s_barrier
    s_add_u32 m0, s68, 98304
    s_add_u32 s49, s46, s80
    buffer_load_dwordx4 v3, s[4:7], s49 offen lds
    s_add_u32 m0, s68, 102400
    s_add_u32 s49, s46, s81
    buffer_load_dwordx4 v3, s[4:7], s49 offen lds
    s_add_u32 m0, s68, 106496
    s_add_u32 s49, s46, s82
    buffer_load_dwordx4 v3, s[4:7], s49 offen lds
    s_add_u32 m0, s68, 110592
    s_add_u32 s49, s46, s83
    buffer_load_dwordx4 v3, s[4:7], s49 offen lds
    s_add_u32 m0, s68, 114688
    s_add_u32 s49, s40, s84
    buffer_load_dwordx4 v3, s[4:7], s49 offen lds
    s_add_u32 m0, s68, 118784
    s_add_u32 s49, s41, s84
    buffer_load_dwordx4 v3, s[4:7], s49 offen lds
    s_mul_i32 s49, s48, 9216
    v_add_u32 v2, s49, v1
    buffer_load_dwordx4 v[32:35], v2, s[8:11], 0 offen
    buffer_load_dwordx4 v[36:39], v2, s[8:11], s60 offen
    s_waitcnt vmcnt(12)
    buffer_load_dwordx4 v[40:43], v2, s[8:11], s61 offen
    v_lshl_or_b32 v64, v68, 8, v64
    v_lshl_or_b32 v72, v76, 8, v72
    v_lshl_or_b32 v16, v72, 16, v64
    v_lshl_or_b32 v65, v69, 8, v65
    v_lshl_or_b32 v73, v77, 8, v73
    v_lshl_or_b32 v18, v73, 16, v65
    buffer_load_dwordx4 v[44:47], v2, s[8:11], s62 offen
    v_lshl_or_b32 v66, v70, 8, v66
    v_lshl_or_b32 v74, v78, 8, v74
    v_lshl_or_b32 v20, v74, 16, v66
    v_lshl_or_b32 v67, v71, 8, v67
    v_lshl_or_b32 v75, v79, 8, v75
    v_lshl_or_b32 v22, v75, 16, v67
    s_waitcnt vmcnt(10)
    s_nop 0
    buffer_load_dwordx4 v[48:51], v2, s[8:11], s63 offen
    v_lshl_or_b32 v80, v84, 8, v80
L_t5:
    s_cbranch_vccnz L_tret
    v_lshl_or_b32 v88, v92, 8, v88
    v_lshl_or_b32 v17, v88, 16, v80
    v_lshl_or_b32 v81, v85, 8, v81
    v_lshl_or_b32 v89, v93, 8, v89
    v_lshl_or_b32 v19, v89, 16, v81
    ds_write_b128 v6, v[16:19] offset:8192
    buffer_load_dwordx4 v[52:55], v2, s[8:11], s64 offen
    v_lshl_or_b32 v82, v86, 8, v82
    v_lshl_or_b32 v90, v94, 8, v90
    v_lshl_or_b32 v21, v90, 16, v82
    v_lshl_or_b32 v83, v87, 8, v83
    v_lshl_or_b32 v91, v95, 8, v91
    v_lshl_or_b32 v23, v91, 16, v83
    ds_write_b128 v7, v[20:23] offset:8192
    buffer_load_dwordx4 v[56:59], v2, s[8:11], s65 offen
    buffer_load_dwordx4 v[60:63], v2, s[8:11], s66 offen
    s_waitcnt vmcnt(8) lgkmcnt(0)
    s_barrier
    s_cmp_lt_u32 s33, 2
    s_cselect_b32 s31, s99, 0
    s_add_u32 m0, s68, 122880
    s_add_u32 s49, s42, s84
    buffer_load_dwordx4 v3, s[4:7], s49 offen lds
    s_add_u32 m0, s68, 126976
    s_add_u32 s49, s43, s84
    buffer_load_dwordx4 v3, s[4:7], s49 offen lds
    s_add_u32 m0, s68, 131072
    s_add_u32 s49, s47, s80
    buffer_load_dwordx4 v3, s[4:7], s49 offen lds
    s_add_u32 m0, s68, 135168
    s_add_u32 s49, s47, s81
    buffer_load_dwordx4 v3, s[4:7], s49 offen lds
    s_add_u32 m0, s68, 139264
    s_add_u32 s49, s47, s82
    buffer_load_dwordx4 v3, s[4:7], s49 offen lds
    s_add_u32 m0, s68, 143360
    s_add_u32 s49, s47, s83
    buffer_load_dwordx4 v3, s[4:7], s49 offen lds
    s_add_u32 m0, s68, 0
    s_add_u32 s49, s44, s84
    buffer_load_dwordx4 v3, s[4:7], s49 offen lds
    s_add_u32 m0, s68, 4096
    s_add_u32 s49, s45, s84
    buffer_load_dwordx4 v3, s[4:7], s49 offen lds
    s_add_u32 m0, s68, 8192
    s_add_u32 s49, s46, s84
    buffer_load_dwordx4 v3, s[4:7], s49 offen lds
    s_waitcnt vmcnt(6)
    s_barrier
    s_waitcnt vmcnt(9)
    v_lshl_or_b32 v32, v36, 8, v32
    v_lshl_or_b32 v40, v44, 8, v40
    v_lshl_or_b32 v16, v40, 16, v32
    v_lshl_or_b32 v48, v52, 8, v48
    v_lshl_or_b32 v56, v60, 8, v56
    v_lshl_or_b32 v17, v56, 16, v48
    v_lshl_or_b32 v33, v37, 8, v33
    v_lshl_or_b32 v41, v45, 8, v41
    v_lshl_or_b32 v18, v41, 16, v33
    v_lshl_or_b32 v49, v53, 8, v49
    v_lshl_or_b32 v57, v61, 8, v57
    v_lshl_or_b32 v19, v57, 16, v49
    ds_write_b128 v6, v[16:19] offset:0
    v_lshl_or_b32 v34, v38, 8, v34
    v_lshl_or_b32 v42, v46, 8, v42
    v_lshl_or_b32 v20, v42, 16, v34
    v_lshl_or_b32 v50, v54, 8, v50
    v_lshl_or_b32 v58, v62, 8, v58
    v_lshl_or_b32 v21, v58, 16, v50
    v_lshl_or_b32 v35, v39, 8, v35
    v_lshl_or_b32 v43, v47, 8, v43
    v_lshl_or_b32 v22, v43, 16, v35
    v_lshl_or_b32 v51, v55, 8, v51
    v_lshl_or_b32 v59, v63, 8, v59
    v_lshl_or_b32 v23, v59, 16, v51
    ds_write_b128 v7, v[20:23] offset:0
    s_add_u32 m0, s68, 12288
    s_add_u32 s49, s47, s84
    buffer_load_dwordx4 v3, s[4:7], s49 offen lds
    s_add_u32 m0, s68, 16384
    s_add_u32 s49, s48, s80
    buffer_load_dwordx4 v3, s[4:7], s49 offen lds
    s_add_u32 m0, s68, 20480
    s_add_u32 s49, s48, s81
    buffer_load_dwordx4 v3, s[4:7], s49 offen lds
    s_waitcnt vmcnt(4) lgkmcnt(0)
    s_barrier
    s_add_u32 m0, s68, 24576
    s_add_u32 s49, s48, s82
    buffer_load_dwordx4 v3, s[4:7], s49 offen lds
    s_add_u32 m0, s68, 28672
    s_add_u32 s49, s48, s83
    buffer_load_dwordx4 v3, s[4:7], s49 offen lds
    s_add_u32 m0, s68, 32768
    s_add_u32 s49, s48, s84
    buffer_load_dwordx4 v3, s[4:7], s49 offen lds
    s_add_u32 m0, s68, 36864
    s_add_u32 s49, s40, s85
    buffer_load_dwordx4 v3, s[4:7], s49 offen lds
    s_add_u32 m0, s68, 40960
    s_add_u32 s49, s41, s85
    buffer_load_dwordx4 v3, s[4:7], s49 offen lds
    s_add_u32 m0, s68, 45056
    s_add_u32 s49, s42, s85
    buffer_load_dwordx4 v3, s[4:7], s49 offen lds
    s_add_u32 m0, s68, 49152
    s_add_u32 s49, s43, s85
    buffer_load_dwordx4 v3, s[4:7], s49 offen lds
    s_add_u32 m0, s68, 53248
    s_add_u32 s49, s44, s85
    buffer_load_dwordx4 v3, s[4:7], s49 offen lds
    s_add_u32 m0, s68, 57344
    s_add_u32 s49, s45, s85
    buffer_load_dwordx4 v3, s[4:7], s49 offen lds
    s_add_u32 m0, s68, 61440
    s_add_u32 s49, s46, s85
    buffer_load_dwordx4 v3, s[4:7], s49 offen lds
    s_waitcnt vmcnt(9)
    s_barrier
    s_add_u32 m0, s68, 65536
    s_add_u32 s49, s47, s85
    buffer_load_dwordx4 v3, s[4:7], s49 offen lds
    s_add_u32 m0, s68, 69632
    s_add_u32 s49, s48, s85
    buffer_load_dwordx4 v3, s[4:7], s49 offen lds
    s_add_u32 m0, s68, 73728
    s_add_u32 s49, s40, s86
    buffer_load_dwordx4 v3, s[4:7], s49 offen lds
    s_add_u32 m0, s68, 77824
    s_add_u32 s49, s41, s86
    buffer_load_dwordx4 v3, s[4:7], s49 offen lds
    s_add_u32 m0, s68, 81920
    s_add_u32 s49, s42, s86
    buffer_load_dwordx4 v3, s[4:7], s49 offen lds
    s_add_u32 m0, s68, 86016
    s_add_u32 s49, s43, s86
    buffer_load_dwordx4 v3, s[4:7], s49 offen lds
    s_add_u32 m0, s68, 90112
    s_add_u32 s49, s44, s86
    buffer_load_dwordx4 v3, s[4:7], s49 offen lds
    s_add_u32 m0, s68, 94208
    s_add_u32 s49, s45, s86
    buffer_load_dwordx4 v3, s[4:7], s49 offen lds
    s_add_u32 m0, s68, 98304
    s_add_u32 s49, s46, s86
    buffer_load_dwordx4 v3, s[4:7], s49 offen lds
    s_add_u32 m0, s68, 102400
    s_add_u32 s49, s47, s86
    buffer_load_dwordx4 v3, s[4:7], s49 offen lds
    s_waitcnt vmcnt(12)
L_t6:
    s_cbranch_vccnz L_tret
    s_barrier
    s_add_u32 m0, s68, 106496
    s_add_u32 s49, s48, s86
    buffer_load_dwordx4 v3, s[4:7], s49 offen lds
    s_add_u32 m0, s68, 110592
    s_add_u32 s49, s40, s87
    buffer_load_dwordx4 v3, s[4:7], s49 offen lds
    s_add_u32 m0, s68, 114688
    s_add_u32 s49, s41, s87
    buffer_load_dwordx4 v3, s[4:7], s49 offen lds
    s_add_u32 m0, s68, 118784
    s_add_u32 s49, s42, s87
    buffer_load_dwordx4 v3, s[4:7], s49 offen lds
    s_add_u32 m0, s68, 122880
    s_add_u32 s49, s43, s87
    buffer_load_dwordx4 v3, s[4:7], s49 offen lds
    s_add_u32 m0, s68, 126976
    s_add_u32 s49, s44, s87
    buffer_load_dwordx4 v3, s[4:7], s49 offen lds
    s_add_u32 m0, s68, 131072
    s_add_u32 s49, s45, s87
    buffer_load_dwordx4 v3, s[4:7], s49 offen lds
    s_add_u32 m0, s68, 135168
    s_add_u32 s49, s46, s87
    buffer_load_dwordx4 v3, s[4:7], s49 offen lds
    s_add_u32 m0, s68, 139264
    s_add_u32 s49, s47, s87
    buffer_load_dwordx4 v3, s[4:7], s49 offen lds
    s_add_u32 m0, s68, 143360
    s_add_u32 s49, s48, s87
    buffer_load_dwordx4 v3, s[4:7], s49 offen lds
    s_add_u32 m0, s68, 0
    s_add_u32 s49, s40, s88
    buffer_load_dwordx4 v3, s[4:7], s49 offen lds
    s_waitcnt vmcnt(16)
    s_barrier
    s_add_u32 m0, s68, 4096
    s_add_u32 s49, s41, s88
    buffer_load_dwordx4 v3, s[4:7], s49 offen lds
    s_add_u32 m0, s68, 8192
    s_add_u32 s49, s42, s88
    buffer_load_dwordx4 v3, s[4:7], s49 offen lds
    s_add_u32 m0, s68, 12288
    s_add_u32 s49, s43, s88
    buffer_load_dwordx4 v3, s[4:7], s49 offen lds
    s_add_u32 m0, s68, 16384
    s_add_u32 s49, s44, s88
    buffer_load_dwordx4 v3, s[4:7], s49 offen lds
    s_add_u32 m0, s68, 20480
    s_add_u32 s49, s45, s88
    buffer_load_dwordx4 v3, s[4:7], s49 offen lds
    s_add_u32 m0, s68, 24576
    s_add_u32 s49, s46, s88
    buffer_load_dwordx4 v3, s[4:7], s49 offen lds
    s_add_u32 m0, s68, 28672
    s_add_u32 s49, s47, s88
    buffer_load_dwordx4 v3, s[4:7], s49 offen lds
    s_add_u32 m0, s68, 32768
    s_add_u32 s49, s48, s88
    buffer_load_dwordx4 v3, s[4:7], s49 offen lds
    s_waitcnt vmcnt(9)
    s_barrier
    s_cmp_eq_u32 s31, 0
    s_cbranch_scc1 L_nohalf
    s_add_u32 m0, s68, 36864
    s_add_u32 s49, s40, s89
    buffer_load_dwordx4 v3, s[4:7], s49 offen lds
    s_add_u32 m0, s68, 40960
    s_add_u32 s49, s41, s89
    buffer_load_dwordx4 v3, s[4:7], s49 offen lds
    s_add_u32 m0, s68, 45056
    s_add_u32 s49, s42, s89
    buffer_load_dwordx4 v3, s[4:7], s49 offen lds
    s_add_u32 m0, s68, 49152
    s_add_u32 s49, s43, s89
    buffer_load_dwordx4 v3, s[4:7], s49 offen lds
    s_add_u32 m0, s68, 53248
    s_add_u32 s49, s44, s89
    buffer_load_dwordx4 v3, s[4:7], s49 offen lds
    s_add_u32 m0, s68, 57344
    s_add_u32 s49, s45, s89
    buffer_load_dwordx4 v3, s[4:7], s49 offen lds
    s_add_u32 m0, s68, 61440
    s_add_u32 s49, s46, s89
    buffer_load_dwordx4 v3, s[4:7], s49 offen lds
    s_add_u32 m0, s68, 65536
    s_add_u32 s49, s47, s89
    buffer_load_dwordx4 v3, s[4:7], s49 offen lds
    s_add_u32 m0, s68, 69632
    s_add_u32 s49, s48, s89
    buffer_load_dwordx4 v3, s[4:7], s49 offen lds
L_nohalf:
    s_waitcnt vmcnt(0)
    s_endpgm
L_cmain:
    s_cbranch_vccnz L_tret
    s_barrier
    s_waitcnt vmcnt(0)
    v_and_b32 v201, s51, v200
    v_lshlrev_b32 v200, 16, v200
    v_mul_f32_e64 v208, -1.0, v200
    v_mul_f32 v209, 0xbf320000, v200
    v_mul_f32 v210, 0xbf060000, v200
    v_mul_f32 v211, 0xbeca0000, v200
    v_mul_f32 v212, 0xbe920000, v200
    v_mul_f32 v213, 0xbe3d0000, v200
    v_mul_f32 v214, 0xbdba0000, v200
    v_mul_f32_e64 v215, 0, v200
    v_mul_f32 v216, 0x3da30000, v200
    v_mul_f32 v217, 0x3e250000, v200
    v_mul_f32 v218, 0x3e7c0000, v200
    v_mul_f32 v219, 0x3ead0000, v200
    v_mul_f32 v220, 0x3ee20000, v200
    v_mul_f32 v221, 0x3f100000, v200
    v_mul_f32 v222, 0x3f390000, v200
    v_mul_f32_e64 v223, 1.0, v200
    v_cvt_pk_bf16_f32 v224, v208, v209
    v_cvt_pk_bf16_f32 v225, v210, v211
    v_cvt_pk_bf16_f32 v226, v212, v213
    v_cvt_pk_bf16_f32 v227, v214, v215
    v_cvt_pk_bf16_f32 v228, v216, v217
    v_cvt_pk_bf16_f32 v229, v218, v219
    v_cvt_pk_bf16_f32 v230, v220, v221
    v_cvt_pk_bf16_f32 v231, v222, v223
    v_perm_b32 v232, v225, v224, s52
    v_perm_b32 v233, v227, v226, s52
    v_perm_b32 v234, v229, v228, s52
    v_perm_b32 v235, v231, v230, s52
    v_perm_b32 v236, v225, v224, s53
    v_perm_b32 v237, v227, v226, s53
    v_perm_b32 v238, v229, v228, s53
    v_perm_b32 v239, v231, v230, s53
    v_xor_b32 v5, s55, v233
    v_xor_b32 v7, s55, v235
    v_xor_b32 v9, s55, v237
    v_xor_b32 v11, s55, v239
    v_perm_b32 v208, v7, v7, s54
    v_perm_b32 v209, v11, v11, s54
    v_xor_b32 v4, v208, v232
    v_xor_b32 v8, v209, v236
    v_perm_b32 v208, v5, v4, s54
    v_perm_b32 v209, v9, v8, s54
    v_xor_b32 v6, v208, v234
    v_xor_b32 v10, v209, v238
    v_perm_b32 v208, v7, v6, s54
    v_perm_b32 v209, v11, v10, s54
    v_xor_b32 v4, v208, v232
    v_xor_b32 v8, v209, v236
    v_perm_b32 v208, v5, v4, s54
    v_perm_b32 v209, v9, v8, s54
    v_xor_b32 v6, v208, v234
    v_xor_b32 v10, v209, v238
    v_mul_f32_e64 v208, -1.0, v201
    v_mul_f32 v209, 0xbf320000, v201
    v_mul_f32 v210, 0xbf060000, v201
    v_mul_f32 v211, 0xbeca0000, v201
    v_mul_f32 v212, 0xbe920000, v201
L_t7:
    s_cbranch_vccnz L_tret
    v_mul_f32 v213, 0xbe3d0000, v201
    v_mul_f32 v214, 0xbdba0000, v201
    v_mul_f32_e64 v215, 0, v201
    v_mul_f32 v216, 0x3da30000, v201
    v_mul_f32 v217, 0x3e250000, v201
    v_mul_f32 v218, 0x3e7c0000, v201
    v_mul_f32 v219, 0x3ead0000, v201
    v_mul_f32 v220, 0x3ee20000, v201
    v_mul_f32 v221, 0x3f100000, v201
    v_mul_f32 v222, 0x3f390000, v201
    v_mul_f32_e64 v223, 1.0, v201
    v_cvt_pk_bf16_f32 v224, v208, v209
    v_cvt_pk_bf16_f32 v225, v210, v211
    v_cvt_pk_bf16_f32 v226, v212, v213
    v_cvt_pk_bf16_f32 v227, v214, v215
    v_cvt_pk_bf16_f32 v228, v216, v217
    v_cvt_pk_bf16_f32 v229, v218, v219
    v_cvt_pk_bf16_f32 v230, v220, v221
    v_cvt_pk_bf16_f32 v231, v222, v223
    v_perm_b32 v232, v225, v224, s52
    v_perm_b32 v233, v227, v226, s52
    v_perm_b32 v234, v229, v228, s52
    v_perm_b32 v235, v231, v230, s52
    v_perm_b32 v236, v225, v224, s53
    v_perm_b32 v237, v227, v226, s53
    v_perm_b32 v238, v229, v228, s53
    v_perm_b32 v239, v231, v230, s53
    v_xor_b32 v25, s55, v233
    v_xor_b32 v27, s55, v235
    v_xor_b32 v29, s55, v237
    v_xor_b32 v31, s55, v239
    v_perm_b32 v208, v27, v27, s54
    v_perm_b32 v209, v31, v31, s54
    v_xor_b32 v24, v208, v232
    v_xor_b32 v28, v209, v236
    v_perm_b32 v208, v25, v24, s54
    v_perm_b32 v209, v29, v28, s54
    v_xor_b32 v26, v208, v234
    v_xor_b32 v30, v209, v238
    v_perm_b32 v208, v27, v26, s54
    v_perm_b32 v209, v31, v30, s54
    v_xor_b32 v24, v208, v232
    v_xor_b32 v28, v209, v236
    v_perm_b32 v208, v25, v24, s54
    v_perm_b32 v209, v29, v28, s54
    v_xor_b32 v26, v208, v234
    v_xor_b32 v30, v209, v238
    ds_read_b128 v[116:119], v3 offset:0
    ds_read_b128 v[124:127], v3 offset:4096
    s_waitcnt lgkmcnt(1)
    v_perm_b32 v112, v5, v4, v116
    v_perm_b32 v113, v9, v8, v116
    v_xor_b32_e64 v116, s58, v116
    v_perm_b32 v240, v7, v6, v116
    v_perm_b32 v116, v11, v10, v116
    v_xor_b32_e64 v240, v112, v240
    v_xor_b32_e64 v116, v113, v116
    v_perm_b32 v112, v116, v240, s56
    v_perm_b32 v113, v116, v240, s57
    v_perm_b32 v114, v5, v4, v117
    v_perm_b32 v115, v9, v8, v117
    v_xor_b32_e64 v117, s58, v117
    v_perm_b32 v242, v7, v6, v117
    v_perm_b32 v117, v11, v10, v117
    v_xor_b32_e64 v242, v114, v242
    v_xor_b32_e64 v117, v115, v117
    v_perm_b32 v114, v117, v242, s56
    v_perm_b32 v115, v117, v242, s57
    v_perm_b32 v116, v25, v24, v118
    v_perm_b32 v117, v29, v28, v118
    v_xor_b32_e64 v118, s58, v118
    v_perm_b32 v244, v27, v26, v118
    v_perm_b32 v118, v31, v30, v118
    v_xor_b32_e64 v244, v116, v244
    v_xor_b32_e64 v118, v117, v118
    v_perm_b32 v116, v118, v244, s56
    v_perm_b32 v117, v118, v244, s57
    v_perm_b32 v118, v25, v24, v119
    v_perm_b32 v247, v29, v28, v119
    v_xor_b32_e64 v119, s58, v119
    v_perm_b32 v246, v27, v26, v119
    v_perm_b32 v119, v31, v30, v119
    v_xor_b32_e64 v246, v118, v246
    v_xor_b32_e64 v119, v247, v119
    v_perm_b32 v118, v119, v246, s56
    v_perm_b32 v119, v119, v246, s57
    s_waitcnt lgkmcnt(0)
    v_perm_b32 v120, v5, v4, v124
    v_perm_b32 v121, v9, v8, v124
    v_xor_b32 v124, s58, v124
    v_perm_b32 v248, v7, v6, v124
    v_perm_b32 v124, v11, v10, v124
    v_xor_b32_e64 v248, v120, v248
    v_xor_b32_e64 v124, v121, v124
    v_perm_b32 v120, v124, v248, s56
    v_perm_b32 v121, v124, v248, s57
    v_perm_b32 v122, v5, v4, v125
    v_perm_b32 v123, v9, v8, v125
    v_xor_b32_e64 v125, s58, v125
    v_perm_b32 v250, v7, v6, v125
    v_perm_b32 v125, v11, v10, v125
    v_xor_b32_e64 v250, v122, v250
    v_xor_b32_e64 v125, v123, v125
    v_perm_b32 v122, v125, v250, s56
    v_perm_b32 v123, v125, v250, s57
    v_perm_b32 v124, v25, v24, v126
    v_perm_b32 v125, v29, v28, v126
    v_xor_b32_e64 v126, s58, v126
    v_perm_b32 v252, v27, v26, v126
    v_perm_b32 v126, v31, v30, v126
    v_xor_b32_e64 v252, v124, v252
    v_xor_b32_e64 v126, v125, v126
    v_perm_b32 v124, v126, v252, s56
    v_perm_b32 v125, v126, v252, s57
    v_perm_b32 v126, v25, v24, v127
    v_perm_b32 v255, v29, v28, v127
    v_xor_b32_e64 v127, s58, v127
    v_perm_b32 v254, v27, v26, v127
    v_perm_b32 v127, v31, v30, v127
    v_xor_b32_e64 v254, v126, v254
    v_xor_b32_e64 v127, v255, v127
    v_perm_b32 v126, v127, v254, s56
    v_perm_b32 v127, v127, v254, s57
    s_add_u32 s65, s99, 18
    s_cmp_ge_u32 s63, s65
    s_cselect_b32 s66, s65, 0
    s_sub_u32 s63, s63, s66
    s_mov_b32 s66, 147456
    s_mul_i32 s80, s63, s66
    s_mul_i32 s65, s65, s66
    s_add_u32 s81, s80, s66
    s_cmp_eq_u32 s81, s65
    s_cselect_b32 s81, 0, s81
    s_add_u32 s82, s81, s66
    s_cmp_eq_u32 s82, s65
    s_cselect_b32 s82, 0, s82
    s_add_u32 s83, s82, s66
    s_cmp_eq_u32 s83, s65
    s_cselect_b32 s83, 0, s83
    s_add_u32 s84, s83, s66
    s_cmp_eq_u32 s84, s65
    s_cselect_b32 s84, 0, s84
    s_add_u32 s85, s84, s66
    s_cmp_eq_u32 s85, s65
    s_cselect_b32 s85, 0, s85
    s_add_u32 s86, s85, s66
L_t8:
    s_cbranch_vccnz L_tret
    s_cmp_eq_u32 s86, s65
    s_cselect_b32 s86, 0, s86
    s_add_u32 s87, s86, s66
    s_cmp_eq_u32 s87, s65
    s_cselect_b32 s87, 0, s87
    s_add_u32 s88, s87, s66
    s_cmp_eq_u32 s88, s65
    s_cselect_b32 s88, 0, s88
    s_add_u32 s89, s88, s66
    s_cmp_eq_u32 s89, s65
    s_cselect_b32 s89, 0, s89
    s_add_u32 s90, s89, s66
    s_cmp_eq_u32 s90, s65
    s_cselect_b32 s90, 0, s90
    s_add_u32 s91, s90, s66
    s_cmp_eq_u32 s91, s65
    s_cselect_b32 s91, 0, s91
    s_add_u32 s92, s91, s66
    s_cmp_eq_u32 s92, s65
    s_cselect_b32 s92, 0, s92
    s_add_u32 s93, s92, s66
    s_cmp_eq_u32 s93, s65
    s_cselect_b32 s93, 0, s93
    s_add_u32 s94, s93, s66
    s_cmp_eq_u32 s94, s65
    s_cselect_b32 s94, 0, s94
    s_add_u32 s95, s94, s66
    s_cmp_eq_u32 s95, s65
    s_cselect_b32 s95, 0, s95
    s_add_u32 s96, s95, s66
    s_cmp_eq_u32 s96, s65
    s_cselect_b32 s96, 0, s96
    s_add_u32 s97, s96, s66
    s_cmp_eq_u32 s97, s65
    s_cselect_b32 s97, 0, s97
    s_add_u32 s98, s97, s66
    s_cmp_eq_u32 s98, s65
    s_cselect_b32 s98, 0, s98
    s_mov_b32 s64, -131072
    s_barrier
    ds_read_b128 v[132:135], v3 offset:8192
    ds_read_b128 v[140:143], v3 offset:12288
    ds_read_b128 v[12:15], v1 offset:0
    ds_read_b128 v[16:19], v1 offset:2048
    s_waitcnt lgkmcnt(1)
    v_mfma_f32_16x16x32_bf16 v[48:51], v[12:15], v[112:115], 0
    ds_read_b128 v[20:23], v2 offset:0
    v_mfma_f32_16x16x32_bf16 v[52:55], v[12:15], v[116:119], 0
    s_waitcnt lgkmcnt(1)
    v_mfma_f32_16x16x32_bf16 v[56:59], v[16:19], v[112:115], 0
    ds_read_b128 v[12:15], v2 offset:2048
    v_perm_b32 v128, v5, v4, v132
    v_perm_b32 v129, v9, v8, v132
    v_mfma_f32_16x16x32_bf16 v[60:63], v[16:19], v[116:119], 0
    v_perm_b32 v130, v5, v4, v133
    v_perm_b32 v131, v9, v8, v133
    v_xor_b32 v132, s58, v132
    s_waitcnt lgkmcnt(1)
    v_mfma_f32_16x16x32_bf16 v[48:51], v[20:23], v[120:123], v[48:51]
    ds_read_b128 v[16:19], v1 offset:4096
    v_perm_b32 v240, v7, v6, v132
    v_perm_b32 v132, v11, v10, v132
    v_mfma_f32_16x16x32_bf16 v[52:55], v[20:23], v[124:127], v[52:55]
    v_xor_b32_e64 v240, v128, v240
    v_xor_b32_e64 v132, v129, v132
    v_xor_b32 v133, s58, v133
    s_waitcnt lgkmcnt(1)
    v_mfma_f32_16x16x32_bf16 v[56:59], v[12:15], v[120:123], v[56:59]
    ds_read_b128 v[20:23], v1 offset:6144
    v_perm_b32 v128, v132, v240, s56
    v_perm_b32 v129, v132, v240, s57
    v_mfma_f32_16x16x32_bf16 v[60:63], v[12:15], v[124:127], v[60:63]
    v_perm_b32 v242, v7, v6, v133
    v_perm_b32 v133, v11, v10, v133
    v_xor_b32 v242, v130, v242
    s_waitcnt lgkmcnt(1)
    v_mfma_f32_16x16x32_bf16 v[64:67], v[16:19], v[112:115], 0
    ds_read_b128 v[12:15], v2 offset:4096
    v_perm_b32 v132, v25, v24, v134
    v_xor_b32_e64 v133, v131, v133
    v_mfma_f32_16x16x32_bf16 v[68:71], v[16:19], v[116:119], 0
    v_perm_b32 v130, v133, v242, s56
    v_perm_b32 v131, v133, v242, s57
    s_waitcnt lgkmcnt(1)
    v_mfma_f32_16x16x32_bf16 v[72:75], v[20:23], v[112:115], 0
    ds_read_b128 v[16:19], v2 offset:6144
    v_perm_b32 v133, v29, v28, v134
    v_perm_b32 v247, v29, v28, v135
    v_mfma_f32_16x16x32_bf16 v[76:79], v[20:23], v[116:119], 0
    v_xor_b32 v134, s58, v134
    v_perm_b32 v244, v27, v26, v134
    v_xor_b32 v244, v132, v244
    s_waitcnt lgkmcnt(1)
    v_mfma_f32_16x16x32_bf16 v[64:67], v[12:15], v[120:123], v[64:67]
    ds_read_b128 v[20:23], v1 offset:8192
    v_perm_b32 v134, v31, v30, v134
    v_xor_b32_e64 v134, v133, v134
    v_mfma_f32_16x16x32_bf16 v[68:71], v[12:15], v[124:127], v[68:71]
    v_perm_b32 v132, v134, v244, s56
    v_perm_b32 v133, v134, v244, s57
    s_waitcnt lgkmcnt(1)
    v_mfma_f32_16x16x32_bf16 v[72:75], v[16:19], v[120:123], v[72:75]
    ds_read_b128 v[12:15], v1 offset:10240
    v_perm_b32 v134, v25, v24, v135
    v_perm_b32 v136, v5, v4, v140
    v_mfma_f32_16x16x32_bf16 v[76:79], v[16:19], v[124:127], v[76:79]
    v_perm_b32 v137, v9, v8, v140
    v_xor_b32 v135, s58, v135
    v_xor_b32 v140, s58, v140
    s_waitcnt lgkmcnt(1)
    v_mfma_f32_16x16x32_bf16 v[80:83], v[20:23], v[112:115], 0
    ds_read_b128 v[16:19], v2 offset:8192
    v_perm_b32 v246, v27, v26, v135
    v_perm_b32 v135, v31, v30, v135
    v_mfma_f32_16x16x32_bf16 v[84:87], v[20:23], v[116:119], 0
    v_perm_b32 v248, v7, v6, v140
    v_perm_b32 v140, v11, v10, v140
    v_xor_b32 v246, v134, v246
    s_waitcnt lgkmcnt(1)
    v_mfma_f32_16x16x32_bf16 v[88:91], v[12:15], v[112:115], 0
    ds_read_b128 v[20:23], v2 offset:10240
    v_perm_b32 v138, v5, v4, v141
    v_perm_b32 v139, v9, v8, v141
    v_mfma_f32_16x16x32_bf16 v[92:95], v[12:15], v[116:119], 0
    v_xor_b32_e64 v135, v247, v135
    v_perm_b32 v134, v135, v246, s56
    v_xor_b32 v248, v136, v248
    s_waitcnt lgkmcnt(1)
    v_mfma_f32_16x16x32_bf16 v[80:83], v[16:19], v[120:123], v[80:83]
    ds_read_b128 v[12:15], v1 offset:12288
    v_perm_b32 v135, v135, v246, s57
    v_xor_b32_e64 v140, v137, v140
    v_mfma_f32_16x16x32_bf16 v[84:87], v[16:19], v[124:127], v[84:87]
    v_perm_b32 v136, v140, v248, s56
    v_perm_b32 v137, v140, v248, s57
    v_xor_b32 v141, s58, v141
    s_waitcnt lgkmcnt(1)
    v_mfma_f32_16x16x32_bf16 v[88:91], v[20:23], v[120:123], v[88:91]
    ds_read_b128 v[16:19], v1 offset:14336
    v_perm_b32 v250, v7, v6, v141
    v_perm_b32 v141, v11, v10, v141
    v_mfma_f32_16x16x32_bf16 v[92:95], v[20:23], v[124:127], v[92:95]
    v_perm_b32 v140, v25, v24, v142
    v_xor_b32_e64 v250, v138, v250
    v_xor_b32 v141, v139, v141
    s_waitcnt lgkmcnt(1)
    v_mfma_f32_16x16x32_bf16 v[96:99], v[12:15], v[112:115], 0
    ds_read_b128 v[20:23], v2 offset:12288
    v_perm_b32 v138, v141, v250, s56
    v_perm_b32 v139, v141, v250, s57
    v_mfma_f32_16x16x32_bf16 v[100:103], v[12:15], v[116:119], 0
    v_perm_b32 v141, v29, v28, v142
    v_perm_b32 v255, v29, v28, v143
    v_xor_b32 v142, s58, v142
    s_waitcnt lgkmcnt(1)
    v_mfma_f32_16x16x32_bf16 v[104:107], v[16:19], v[112:115], 0
    ds_read_b128 v[12:15], v2 offset:14336
    v_perm_b32 v252, v27, v26, v142
    v_perm_b32 v142, v31, v30, v142
    v_mfma_f32_16x16x32_bf16 v[108:111], v[16:19], v[116:119], 0
L_t9:
    s_cbranch_vccnz L_tret
    v_xor_b32 v252, v140, v252
    v_xor_b32_e64 v142, v141, v142
    s_waitcnt lgkmcnt(1)
    v_mfma_f32_16x16x32_bf16 v[96:99], v[20:23], v[120:123], v[96:99]
    s_barrier
    ds_read_b128 v[148:151], v3 offset:0
    ds_read_b128 v[156:159], v3 offset:4096
    ds_read_b128 v[16:19], v1 offset:16384
    v_perm_b32 v140, v142, v252, s56
    v_perm_b32 v141, v142, v252, s57
    v_mfma_f32_16x16x32_bf16 v[100:103], v[20:23], v[124:127], v[100:103]
    v_perm_b32 v142, v25, v24, v143
    v_xor_b32_e64 v143, s58, v143
    s_waitcnt lgkmcnt(3)
    v_mfma_f32_16x16x32_bf16 v[104:107], v[12:15], v[120:123], v[104:107]
    ds_read_b128 v[20:23], v1 offset:18432
    v_perm_b32 v254, v27, v26, v143
    v_perm_b32 v143, v31, v30, v143
    v_mfma_f32_16x16x32_bf16 v[108:111], v[12:15], v[124:127], v[108:111]
    s_waitcnt lgkmcnt(3)
    v_perm_b32 v144, v5, v4, v148
    v_perm_b32 v145, v9, v8, v148
    v_xor_b32 v254, v142, v254
    s_waitcnt lgkmcnt(1)
    v_mfma_f32_16x16x32_bf16 v[48:51], v[16:19], v[128:131], v[48:51]
    ds_read_b128 v[12:15], v2 offset:16384
    v_xor_b32_e64 v143, v255, v143
    v_perm_b32 v142, v143, v254, s56
    v_mfma_f32_16x16x32_bf16 v[52:55], v[16:19], v[132:135], v[52:55]
    v_perm_b32 v143, v143, v254, s57
    v_perm_b32 v146, v5, v4, v149
    v_xor_b32 v148, s58, v148
    s_waitcnt lgkmcnt(1)
    v_mfma_f32_16x16x32_bf16 v[56:59], v[20:23], v[128:131], v[56:59]
    ds_read_b128 v[16:19], v2 offset:18432
    v_perm_b32 v240, v7, v6, v148
    v_perm_b32 v148, v11, v10, v148
    v_mfma_f32_16x16x32_bf16 v[60:63], v[20:23], v[132:135], v[60:63]
    v_perm_b32 v147, v9, v8, v149
    v_xor_b32_e64 v240, v144, v240
    v_xor_b32 v148, v145, v148
    s_waitcnt lgkmcnt(1)
    v_mfma_f32_16x16x32_bf16 v[48:51], v[12:15], v[136:139], v[48:51]
    ds_read_b128 v[20:23], v1 offset:20480
    v_perm_b32 v144, v148, v240, s56
    v_perm_b32 v145, v148, v240, s57
    v_mfma_f32_16x16x32_bf16 v[52:55], v[12:15], v[140:143], v[52:55]
    v_perm_b32 v148, v25, v24, v150
    v_xor_b32_e64 v149, s58, v149
    s_waitcnt lgkmcnt(1)
    v_mfma_f32_16x16x32_bf16 v[56:59], v[16:19], v[136:139], v[56:59]
    ds_read_b128 v[12:15], v1 offset:22528
    v_perm_b32 v242, v7, v6, v149
    v_perm_b32 v149, v11, v10, v149
    v_mfma_f32_16x16x32_bf16 v[60:63], v[16:19], v[140:143], v[60:63]
    v_xor_b32 v242, v146, v242
    v_xor_b32_e64 v149, v147, v149
    s_waitcnt lgkmcnt(1)
    v_mfma_f32_16x16x32_bf16 v[64:67], v[20:23], v[128:131], v[64:67]
    ds_read_b128 v[16:19], v2 offset:20480
    v_perm_b32 v146, v149, v242, s56
    v_perm_b32 v147, v149, v242, s57
    v_mfma_f32_16x16x32_bf16 v[68:71], v[20:23], v[132:135], v[68:71]
    v_perm_b32 v149, v29, v28, v150
    v_perm_b32 v247, v29, v28, v151
    v_xor_b32 v150, s58, v150
    s_waitcnt lgkmcnt(1)
    v_mfma_f32_16x16x32_bf16 v[72:75], v[12:15], v[128:131], v[72:75]
    ds_read_b128 v[20:23], v2 offset:22528
    v_perm_b32 v244, v27, v26, v150
    v_perm_b32 v150, v31, v30, v150
    v_mfma_f32_16x16x32_bf16 v[76:79], v[12:15], v[132:135], v[76:79]
    v_xor_b32 v244, v148, v244
    v_xor_b32_e64 v150, v149, v150
    s_waitcnt lgkmcnt(1)
    v_mfma_f32_16x16x32_bf16 v[64:67], v[16:19], v[136:139], v[64:67]
    ds_read_b128 v[12:15], v1 offset:24576
    v_perm_b32 v148, v150, v244, s56
    v_perm_b32 v149, v150, v244, s57
    v_mfma_f32_16x16x32_bf16 v[68:71], v[16:19], v[140:143], v[68:71]
    v_perm_b32 v150, v25, v24, v151
    v_perm_b32 v152, v5, v4, v156
    v_perm_b32 v153, v9, v8, v156
    s_waitcnt lgkmcnt(1)
    v_mfma_f32_16x16x32_bf16 v[72:75], v[20:23], v[136:139], v[72:75]
    ds_read_b128 v[16:19], v1 offset:26624
    v_xor_b32_e64 v151, s58, v151
    v_perm_b32 v246, v27, v26, v151
    v_mfma_f32_16x16x32_bf16 v[76:79], v[20:23], v[140:143], v[76:79]
    v_perm_b32 v151, v31, v30, v151
    v_xor_b32_e64 v246, v150, v246
    v_xor_b32 v151, v247, v151
    s_waitcnt lgkmcnt(1)
    v_mfma_f32_16x16x32_bf16 v[80:83], v[12:15], v[128:131], v[80:83]
    ds_read_b128 v[20:23], v2 offset:24576
    v_perm_b32 v150, v151, v246, s56
    v_perm_b32 v151, v151, v246, s57
    v_mfma_f32_16x16x32_bf16 v[84:87], v[12:15], v[132:135], v[84:87]
    v_perm_b32 v154, v5, v4, v157
    v_perm_b32 v155, v9, v8, v157
    v_xor_b32 v156, s58, v156
    s_waitcnt lgkmcnt(1)
    v_mfma_f32_16x16x32_bf16 v[88:91], v[16:19], v[128:131], v[88:91]
    ds_read_b128 v[12:15], v2 offset:26624
    v_perm_b32 v248, v7, v6, v156
    v_perm_b32 v156, v11, v10, v156
    v_mfma_f32_16x16x32_bf16 v[92:95], v[16:19], v[132:135], v[92:95]
    v_xor_b32_e64 v248, v152, v248
    v_xor_b32_e64 v156, v153, v156
    v_xor_b32 v157, s58, v157
    s_waitcnt lgkmcnt(1)
    v_mfma_f32_16x16x32_bf16 v[80:83], v[20:23], v[136:139], v[80:83]
    ds_read_b128 v[16:19], v1 offset:28672
    v_perm_b32 v152, v156, v248, s56
    v_perm_b32 v153, v156, v248, s57
    v_mfma_f32_16x16x32_bf16 v[84:87], v[20:23], v[140:143], v[84:87]
    v_perm_b32 v250, v7, v6, v157
    v_perm_b32 v157, v11, v10, v157
    v_xor_b32 v250, v154, v250
    s_waitcnt lgkmcnt(1)
    v_mfma_f32_16x16x32_bf16 v[88:91], v[12:15], v[136:139], v[88:91]
    ds_read_b128 v[20:23], v1 offset:30720
    v_perm_b32 v156, v25, v24, v158
    v_xor_b32_e64 v157, v155, v157
    v_mfma_f32_16x16x32_bf16 v[92:95], v[12:15], v[140:143], v[92:95]
    v_perm_b32 v154, v157, v250, s56
    v_perm_b32 v155, v157, v250, s57
    s_waitcnt lgkmcnt(1)
    v_mfma_f32_16x16x32_bf16 v[96:99], v[16:19], v[128:131], v[96:99]
    ds_read_b128 v[12:15], v2 offset:28672
    v_perm_b32 v157, v29, v28, v158
    v_perm_b32 v255, v29, v28, v159
    v_mfma_f32_16x16x32_bf16 v[100:103], v[16:19], v[132:135], v[100:103]
    v_xor_b32 v158, s58, v158
    v_perm_b32 v252, v27, v26, v158
    v_xor_b32 v252, v156, v252
    s_waitcnt lgkmcnt(1)
    v_mfma_f32_16x16x32_bf16 v[104:107], v[20:23], v[128:131], v[104:107]
    ds_read_b128 v[16:19], v2 offset:30720
    v_perm_b32 v158, v31, v30, v158
    v_xor_b32_e64 v158, v157, v158
    v_mfma_f32_16x16x32_bf16 v[108:111], v[20:23], v[132:135], v[108:111]
    v_perm_b32 v156, v158, v252, s56
L_t10:
    s_cbranch_vccnz L_tret
    v_perm_b32 v157, v158, v252, s57
    v_perm_b32 v158, v25, v24, v159
    s_waitcnt lgkmcnt(1)
    v_mfma_f32_16x16x32_bf16 v[96:99], v[12:15], v[136:139], v[96:99]
    s_barrier
    ds_read_b128 v[164:167], v3 offset:8192
    ds_read_b128 v[172:175], v3 offset:12288
    ds_read_b128 v[20:23], v1 offset:32768
    v_xor_b32 v159, s58, v159
    v_perm_b32 v254, v27, v26, v159
    v_mfma_f32_16x16x32_bf16 v[100:103], v[12:15], v[140:143], v[100:103]
    v_perm_b32 v159, v31, v30, v159
    v_xor_b32_e64 v254, v158, v254
    v_xor_b32 v159, v255, v159
    s_waitcnt lgkmcnt(3)
    v_mfma_f32_16x16x32_bf16 v[104:107], v[16:19], v[136:139], v[104:107]
    ds_read_b128 v[12:15], v1 offset:34816
    v_perm_b32 v158, v159, v254, s56
    v_perm_b32 v159, v159, v254, s57
    v_mfma_f32_16x16x32_bf16 v[108:111], v[16:19], v[140:143], v[108:111]
    s_waitcnt lgkmcnt(3)
    v_perm_b32 v160, v5, v4, v164
    v_perm_b32 v161, v9, v8, v164
    v_perm_b32 v162, v5, v4, v165
    s_waitcnt lgkmcnt(1)
    v_mfma_f32_16x16x32_bf16 v[48:51], v[20:23], v[144:147], v[48:51]
    ds_read_b128 v[16:19], v2 offset:32768
    v_perm_b32 v163, v9, v8, v165
    v_xor_b32_e64 v164, s58, v164
    v_mfma_f32_16x16x32_bf16 v[52:55], v[20:23], v[148:151], v[52:55]
    v_perm_b32 v240, v7, v6, v164
    v_perm_b32 v164, v11, v10, v164
    v_xor_b32 v240, v160, v240
    s_waitcnt lgkmcnt(1)
    v_mfma_f32_16x16x32_bf16 v[56:59], v[12:15], v[144:147], v[56:59]
    ds_read_b128 v[20:23], v2 offset:34816
    v_xor_b32_e64 v164, v161, v164
    v_perm_b32 v160, v164, v240, s56
    v_mfma_f32_16x16x32_bf16 v[60:63], v[12:15], v[148:151], v[60:63]
    v_perm_b32 v161, v164, v240, s57
    v_perm_b32 v164, v25, v24, v166
    v_xor_b32 v165, s58, v165
    s_waitcnt lgkmcnt(1)
    v_mfma_f32_16x16x32_bf16 v[48:51], v[16:19], v[152:155], v[48:51]
    ds_read_b128 v[12:15], v1 offset:36864
    v_perm_b32 v242, v7, v6, v165
    v_perm_b32 v165, v11, v10, v165
    v_mfma_f32_16x16x32_bf16 v[52:55], v[16:19], v[156:159], v[52:55]
    v_xor_b32_e64 v242, v162, v242
    v_xor_b32_e64 v165, v163, v165
    s_waitcnt lgkmcnt(1)
    v_mfma_f32_16x16x32_bf16 v[56:59], v[20:23], v[152:155], v[56:59]
    ds_read_b128 v[16:19], v1 offset:38912
    v_perm_b32 v162, v165, v242, s56
    v_perm_b32 v163, v165, v242, s57
    v_mfma_f32_16x16x32_bf16 v[60:63], v[20:23], v[156:159], v[60:63]
    v_perm_b32 v165, v29, v28, v166
    v_perm_b32 v247, v29, v28, v167
    v_xor_b32 v166, s58, v166
    s_waitcnt lgkmcnt(1)
    v_mfma_f32_16x16x32_bf16 v[64:67], v[12:15], v[144:147], v[64:67]
    ds_read_b128 v[20:23], v2 offset:36864
    v_perm_b32 v244, v27, v26, v166
    v_perm_b32 v166, v31, v30, v166
    v_mfma_f32_16x16x32_bf16 v[68:71], v[12:15], v[148:151], v[68:71]
    v_xor_b32 v244, v164, v244
    v_xor_b32_e64 v166, v165, v166
    s_waitcnt lgkmcnt(1)
    v_mfma_f32_16x16x32_bf16 v[72:75], v[16:19], v[144:147], v[72:75]
    ds_read_b128 v[12:15], v2 offset:38912
    v_perm_b32 v164, v166, v244, s56
    v_perm_b32 v165, v166, v244, s57
    v_mfma_f32_16x16x32_bf16 v[76:79], v[16:19], v[148:151], v[76:79]
    v_perm_b32 v166, v25, v24, v167
    v_perm_b32 v168, v5, v4, v172
    v_perm_b32 v169, v9, v8, v172
    s_waitcnt lgkmcnt(1)
    v_mfma_f32_16x16x32_bf16 v[64:67], v[20:23], v[152:155], v[64:67]
    ds_read_b128 v[16:19], v1 offset:40960
    v_xor_b32_e64 v167, s58, v167
    v_perm_b32 v246, v27, v26, v167
    v_mfma_f32_16x16x32_bf16 v[68:71], v[20:23], v[156:159], v[68:71]
    v_perm_b32 v167, v31, v30, v167
    v_xor_b32_e64 v246, v166, v246
    v_xor_b32 v167, v247, v167
    s_waitcnt lgkmcnt(1)
    v_mfma_f32_16x16x32_bf16 v[72:75], v[12:15], v[152:155], v[72:75]
    ds_read_b128 v[20:23], v1 offset:43008
    v_perm_b32 v166, v167, v246, s56
    v_perm_b32 v167, v167, v246, s57
    v_mfma_f32_16x16x32_bf16 v[76:79], v[12:15], v[156:159], v[76:79]
    v_perm_b32 v170, v5, v4, v173
    v_perm_b32 v171, v9, v8, v173
    v_xor_b32 v172, s58, v172
    s_waitcnt lgkmcnt(1)
    v_mfma_f32_16x16x32_bf16 v[80:83], v[16:19], v[144:147], v[80:83]
    ds_read_b128 v[12:15], v2 offset:40960
    v_perm_b32 v248, v7, v6, v172
    v_perm_b32 v172, v11, v10, v172
    v_mfma_f32_16x16x32_bf16 v[84:87], v[16:19], v[148:151], v[84:87]
    v_xor_b32_e64 v248, v168, v248
    v_xor_b32_e64 v172, v169, v172
    v_xor_b32 v173, s58, v173
    s_waitcnt lgkmcnt(1)
    v_mfma_f32_16x16x32_bf16 v[88:91], v[20:23], v[144:147], v[88:91]
    ds_read_b128 v[16:19], v2 offset:43008
    v_perm_b32 v168, v172, v248, s56
    v_perm_b32 v169, v172, v248, s57
    v_mfma_f32_16x16x32_bf16 v[92:95], v[20:23], v[148:151], v[92:95]
    v_perm_b32 v250, v7, v6, v173
    v_perm_b32 v173, v11, v10, v173
    v_xor_b32 v250, v170, v250
    s_waitcnt lgkmcnt(1)
    v_mfma_f32_16x16x32_bf16 v[80:83], v[12:15], v[152:155], v[80:83]
    ds_read_b128 v[20:23], v1 offset:45056
    v_perm_b32 v172, v25, v24, v174
    v_xor_b32_e64 v173, v171, v173
    v_mfma_f32_16x16x32_bf16 v[84:87], v[12:15], v[156:159], v[84:87]
    v_perm_b32 v170, v173, v250, s56
    v_perm_b32 v171, v173, v250, s57
    s_waitcnt lgkmcnt(1)
    v_mfma_f32_16x16x32_bf16 v[88:91], v[16:19], v[152:155], v[88:91]
    ds_read_b128 v[12:15], v1 offset:47104
    v_perm_b32 v173, v29, v28, v174
    v_perm_b32 v255, v29, v28, v175
    v_mfma_f32_16x16x32_bf16 v[92:95], v[16:19], v[156:159], v[92:95]
    v_xor_b32 v174, s58, v174
    v_perm_b32 v252, v27, v26, v174
    v_xor_b32 v252, v172, v252
    s_waitcnt lgkmcnt(1)
    v_mfma_f32_16x16x32_bf16 v[96:99], v[20:23], v[144:147], v[96:99]
    ds_read_b128 v[16:19], v2 offset:45056
    v_perm_b32 v174, v31, v30, v174
    v_xor_b32_e64 v174, v173, v174
    v_mfma_f32_16x16x32_bf16 v[100:103], v[20:23], v[148:151], v[100:103]
    v_perm_b32 v172, v174, v252, s56
    v_perm_b32 v173, v174, v252, s57
    s_waitcnt lgkmcnt(1)
    v_mfma_f32_16x16x32_bf16 v[104:107], v[12:15], v[144:147], v[104:107]
    ds_read_b128 v[20:23], v2 offset:47104
    v_perm_b32 v174, v25, v24, v175
    v_xor_b32 v175, s58, v175
    v_mfma_f32_16x16x32_bf16 v[108:111], v[12:15], v[148:151], v[108:111]
L_t11:
    s_cbranch_vccnz L_tret
    v_perm_b32 v254, v27, v26, v175
    v_perm_b32 v175, v31, v30, v175
    v_xor_b32 v254, v174, v254
    s_waitcnt lgkmcnt(1)
    v_mfma_f32_16x16x32_bf16 v[96:99], v[16:19], v[152:155], v[96:99]
    s_barrier
    ds_read_b128 v[180:183], v3 offset:0
    ds_read_b128 v[188:191], v3 offset:4096
    ds_read_b128 v[12:15], v1 offset:49152
    v_xor_b32_e64 v175, v255, v175
    v_perm_b32 v174, v175, v254, s56
    v_mfma_f32_16x16x32_bf16 v[100:103], v[16:19], v[156:159], v[100:103]
    v_perm_b32 v175, v175, v254, s57
    s_waitcnt lgkmcnt(3)
    v_mfma_f32_16x16x32_bf16 v[104:107], v[20:23], v[152:155], v[104:107]
    ds_read_b128 v[16:19], v1 offset:51200
    v_mfma_f32_16x16x32_bf16 v[108:111], v[20:23], v[156:159], v[108:111]
    s_waitcnt lgkmcnt(3)
    v_perm_b32 v176, v5, v4, v180
    v_perm_b32 v177, v9, v8, v180
    v_xor_b32 v180, s58, v180
    s_waitcnt lgkmcnt(1)
    v_mfma_f32_16x16x32_bf16 v[48:51], v[12:15], v[160:163], v[48:51]
    ds_read_b128 v[20:23], v2 offset:49152
    v_perm_b32 v240, v7, v6, v180
    v_perm_b32 v180, v11, v10, v180
    v_mfma_f32_16x16x32_bf16 v[52:55], v[12:15], v[164:167], v[52:55]
    v_perm_b32 v178, v5, v4, v181
    v_perm_b32 v179, v9, v8, v181
    v_xor_b32 v240, v176, v240
    s_waitcnt lgkmcnt(1)
    v_mfma_f32_16x16x32_bf16 v[56:59], v[16:19], v[160:163], v[56:59]
    ds_read_b128 v[12:15], v2 offset:51200
    v_xor_b32_e64 v180, v177, v180
    v_perm_b32 v176, v180, v240, s56
    v_mfma_f32_16x16x32_bf16 v[60:63], v[16:19], v[164:167], v[60:63]
    v_perm_b32 v177, v180, v240, s57
    v_perm_b32 v180, v25, v24, v182
    v_xor_b32 v181, s58, v181
    s_waitcnt lgkmcnt(1)
    v_mfma_f32_16x16x32_bf16 v[48:51], v[20:23], v[168:171], v[48:51]
    ds_read_b128 v[16:19], v1 offset:53248
    v_perm_b32 v242, v7, v6, v181
    v_perm_b32 v181, v11, v10, v181
    v_mfma_f32_16x16x32_bf16 v[52:55], v[20:23], v[172:175], v[52:55]
    v_xor_b32_e64 v242, v178, v242
    v_xor_b32_e64 v181, v179, v181
    s_waitcnt lgkmcnt(1)
    v_mfma_f32_16x16x32_bf16 v[56:59], v[12:15], v[168:171], v[56:59]
    ds_read_b128 v[20:23], v1 offset:55296
    v_perm_b32 v178, v181, v242, s56
    v_perm_b32 v179, v181, v242, s57
    v_mfma_f32_16x16x32_bf16 v[60:63], v[12:15], v[172:175], v[60:63]
    v_perm_b32 v181, v29, v28, v182
    v_perm_b32 v247, v29, v28, v183
    v_xor_b32 v182, s58, v182
    s_waitcnt lgkmcnt(1)
    v_mfma_f32_16x16x32_bf16 v[64:67], v[16:19], v[160:163], v[64:67]
    ds_read_b128 v[12:15], v2 offset:53248
    v_perm_b32 v244, v27, v26, v182
    v_perm_b32 v182, v31, v30, v182
    v_mfma_f32_16x16x32_bf16 v[68:71], v[16:19], v[164:167], v[68:71]
    v_xor_b32 v244, v180, v244
    v_xor_b32_e64 v182, v181, v182
    s_waitcnt lgkmcnt(1)
    v_mfma_f32_16x16x32_bf16 v[72:75], v[20:23], v[160:163], v[72:75]
    ds_read_b128 v[16:19], v2 offset:55296
    v_perm_b32 v180, v182, v244, s56
    v_perm_b32 v181, v182, v244, s57
    v_mfma_f32_16x16x32_bf16 v[76:79], v[20:23], v[164:167], v[76:79]
    v_perm_b32 v182, v25, v24, v183
    v_perm_b32 v184, v5, v4, v188
    v_perm_b32 v185, v9, v8, v188
    s_waitcnt lgkmcnt(1)
    v_mfma_f32_16x16x32_bf16 v[64:67], v[12:15], v[168:171], v[64:67]
    ds_read_b128 v[20:23], v1 offset:57344
    v_xor_b32_e64 v183, s58, v183
    v_perm_b32 v246, v27, v26, v183
    v_mfma_f32_16x16x32_bf16 v[68:71], v[12:15], v[172:175], v[68:71]
    v_perm_b32 v183, v31, v30, v183
    v_xor_b32_e64 v246, v182, v246
    v_xor_b32 v183, v247, v183
    s_waitcnt lgkmcnt(1)
    v_mfma_f32_16x16x32_bf16 v[72:75], v[16:19], v[168:171], v[72:75]
    ds_read_b128 v[12:15], v1 offset:59392
    v_perm_b32 v182, v183, v246, s56
    v_perm_b32 v183, v183, v246, s57
    v_mfma_f32_16x16x32_bf16 v[76:79], v[16:19], v[172:175], v[76:79]
    v_perm_b32 v186, v5, v4, v189
    v_perm_b32 v187, v9, v8, v189
    v_xor_b32 v188, s58, v188
    s_waitcnt lgkmcnt(1)
    v_mfma_f32_16x16x32_bf16 v[80:83], v[20:23], v[160:163], v[80:83]
    ds_read_b128 v[16:19], v2 offset:57344
    v_perm_b32 v248, v7, v6, v188
    v_perm_b32 v188, v11, v10, v188
    v_mfma_f32_16x16x32_bf16 v[84:87], v[20:23], v[164:167], v[84:87]
    v_xor_b32_e64 v248, v184, v248
    v_xor_b32_e64 v188, v185, v188
    v_xor_b32 v189, s58, v189
    s_waitcnt lgkmcnt(1)
    v_mfma_f32_16x16x32_bf16 v[88:91], v[12:15], v[160:163], v[88:91]
    ds_read_b128 v[20:23], v2 offset:59392
    v_perm_b32 v184, v188, v248, s56
    v_perm_b32 v185, v188, v248, s57
    v_mfma_f32_16x16x32_bf16 v[92:95], v[12:15], v[164:167], v[92:95]
    v_perm_b32 v250, v7, v6, v189
    v_perm_b32 v189, v11, v10, v189
    v_xor_b32 v250, v186, v250
    s_waitcnt lgkmcnt(1)
    v_mfma_f32_16x16x32_bf16 v[80:83], v[16:19], v[168:171], v[80:83]
    ds_read_b128 v[12:15], v1 offset:61440
    v_perm_b32 v188, v25, v24, v190
    v_xor_b32_e64 v189, v187, v189
    v_mfma_f32_16x16x32_bf16 v[84:87], v[16:19], v[172:175], v[84:87]
    v_perm_b32 v186, v189, v250, s56
    v_perm_b32 v187, v189, v250, s57
    s_waitcnt lgkmcnt(1)
    v_mfma_f32_16x16x32_bf16 v[88:91], v[20:23], v[168:171], v[88:91]
    ds_read_b128 v[16:19], v1 offset:63488
    v_perm_b32 v189, v29, v28, v190
    v_perm_b32 v255, v29, v28, v191
    v_mfma_f32_16x16x32_bf16 v[92:95], v[20:23], v[172:175], v[92:95]
    v_xor_b32 v190, s58, v190
    v_perm_b32 v252, v27, v26, v190
    v_xor_b32 v252, v188, v252
    s_waitcnt lgkmcnt(1)
    v_mfma_f32_16x16x32_bf16 v[96:99], v[12:15], v[160:163], v[96:99]
    ds_read_b128 v[20:23], v2 offset:61440
    v_perm_b32 v190, v31, v30, v190
    v_xor_b32_e64 v190, v189, v190
    v_mfma_f32_16x16x32_bf16 v[100:103], v[12:15], v[164:167], v[100:103]
    v_perm_b32 v188, v190, v252, s56
    v_perm_b32 v189, v190, v252, s57
    s_waitcnt lgkmcnt(1)
    v_mfma_f32_16x16x32_bf16 v[104:107], v[16:19], v[160:163], v[104:107]
    ds_read_b128 v[12:15], v2 offset:63488
    v_perm_b32 v190, v25, v24, v191
    v_xor_b32 v191, s58, v191
    v_mfma_f32_16x16x32_bf16 v[108:111], v[16:19], v[164:167], v[108:111]
    v_perm_b32 v254, v27, v26, v191
    v_perm_b32 v191, v31, v30, v191
    v_xor_b32 v254, v190, v254
    s_waitcnt lgkmcnt(1)
L_t12:
    s_cbranch_vccnz L_tret
    v_mfma_f32_16x16x32_bf16 v[96:99], v[20:23], v[168:171], v[96:99]
    s_barrier
    ds_read_b128 v[196:199], v3 offset:8192
    ds_read_b128 v[204:207], v3 offset:12288
    v_add_u32 v1, s59, v1
    v_add_u32 v2, s59, v2
    ds_read_b128 v[16:19], v1 offset:0
    v_xor_b32_e64 v191, v255, v191
    v_perm_b32 v190, v191, v254, s56
    v_mfma_f32_16x16x32_bf16 v[100:103], v[20:23], v[172:175], v[100:103]
    v_perm_b32 v191, v191, v254, s57
    s_waitcnt lgkmcnt(3)
    v_mfma_f32_16x16x32_bf16 v[104:107], v[12:15], v[168:171], v[104:107]
    ds_read_b128 v[20:23], v1 offset:2048
    v_mfma_f32_16x16x32_bf16 v[108:111], v[12:15], v[172:175], v[108:111]
    s_waitcnt lgkmcnt(3)
    v_perm_b32 v192, v5, v4, v196
    v_perm_b32 v193, v9, v8, v196
    v_xor_b32 v196, s58, v196
    s_waitcnt lgkmcnt(1)
    v_mfma_f32_16x16x32_bf16 v[48:51], v[16:19], v[176:179], v[48:51]
    ds_read_b128 v[12:15], v2 offset:0
    v_perm_b32 v240, v7, v6, v196
    v_perm_b32 v196, v11, v10, v196
    v_mfma_f32_16x16x32_bf16 v[52:55], v[16:19], v[180:183], v[52:55]
    v_perm_b32 v194, v5, v4, v197
    v_perm_b32 v195, v9, v8, v197
    v_xor_b32 v240, v192, v240
    s_waitcnt lgkmcnt(1)
    v_mfma_f32_16x16x32_bf16 v[56:59], v[20:23], v[176:179], v[56:59]
    ds_read_b128 v[16:19], v2 offset:2048
    v_xor_b32_e64 v196, v193, v196
    v_perm_b32 v192, v196, v240, s56
    v_mfma_f32_16x16x32_bf16 v[60:63], v[20:23], v[180:183], v[60:63]
    v_perm_b32 v193, v196, v240, s57
    v_perm_b32 v196, v25, v24, v198
    v_xor_b32 v197, s58, v197
    s_waitcnt lgkmcnt(1)
    v_mfma_f32_16x16x32_bf16 v[48:51], v[12:15], v[184:187], v[48:51]
    ds_read_b128 v[20:23], v1 offset:4096
    v_perm_b32 v242, v7, v6, v197
    v_perm_b32 v197, v11, v10, v197
    v_mfma_f32_16x16x32_bf16 v[52:55], v[12:15], v[188:191], v[52:55]
    v_xor_b32_e64 v242, v194, v242
    v_xor_b32_e64 v197, v195, v197
    s_waitcnt lgkmcnt(1)
    v_mfma_f32_16x16x32_bf16 v[56:59], v[16:19], v[184:187], v[56:59]
    ds_read_b128 v[12:15], v1 offset:6144
    v_perm_b32 v194, v197, v242, s56
    v_perm_b32 v195, v197, v242, s57
    v_mfma_f32_16x16x32_bf16 v[60:63], v[16:19], v[188:191], v[60:63]
    v_perm_b32 v197, v29, v28, v198
    v_perm_b32 v247, v29, v28, v199
    v_xor_b32 v198, s58, v198
    s_waitcnt lgkmcnt(1)
    v_mfma_f32_16x16x32_bf16 v[64:67], v[20:23], v[176:179], v[64:67]
    ds_read_b128 v[16:19], v2 offset:4096
    v_perm_b32 v244, v27, v26, v198
    v_perm_b32 v198, v31, v30, v198
    v_mfma_f32_16x16x32_bf16 v[68:71], v[20:23], v[180:183], v[68:71]
    v_xor_b32 v244, v196, v244
    v_xor_b32_e64 v198, v197, v198
    s_waitcnt lgkmcnt(1)
    v_mfma_f32_16x16x32_bf16 v[72:75], v[12:15], v[176:179], v[72:75]
    ds_read_b128 v[20:23], v2 offset:6144
    v_perm_b32 v196, v198, v244, s56
    v_perm_b32 v197, v198, v244, s57
    v_mfma_f32_16x16x32_bf16 v[76:79], v[12:15], v[180:183], v[76:79]
    v_perm_b32 v198, v25, v24, v199
    v_perm_b32 v200, v5, v4, v204
    v_perm_b32 v201, v9, v8, v204
    s_waitcnt lgkmcnt(1)
    v_mfma_f32_16x16x32_bf16 v[64:67], v[16:19], v[184:187], v[64:67]
    ds_read_b128 v[12:15], v1 offset:8192
    v_xor_b32_e64 v199, s58, v199
    v_perm_b32 v246, v27, v26, v199
    v_mfma_f32_16x16x32_bf16 v[68:71], v[16:19], v[188:191], v[68:71]
    v_perm_b32 v199, v31, v30, v199
    v_xor_b32_e64 v246, v198, v246
    v_xor_b32 v199, v247, v199
    s_waitcnt lgkmcnt(1)
    v_mfma_f32_16x16x32_bf16 v[72:75], v[20:23], v[184:187], v[72:75]
    ds_read_b128 v[16:19], v1 offset:10240
    v_perm_b32 v198, v199, v246, s56
    v_perm_b32 v199, v199, v246, s57
    v_mfma_f32_16x16x32_bf16 v[76:79], v[20:23], v[188:191], v[76:79]
    v_perm_b32 v202, v5, v4, v205
    v_perm_b32 v203, v9, v8, v205
    v_xor_b32 v204, s58, v204
    s_waitcnt lgkmcnt(1)
    v_mfma_f32_16x16x32_bf16 v[80:83], v[12:15], v[176:179], v[80:83]
    ds_read_b128 v[20:23], v2 offset:8192
    v_perm_b32 v248, v7, v6, v204
    v_perm_b32 v204, v11, v10, v204
    v_mfma_f32_16x16x32_bf16 v[84:87], v[12:15], v[180:183], v[84:87]
    v_xor_b32_e64 v248, v200, v248
    v_xor_b32_e64 v204, v201, v204
    v_xor_b32 v205, s58, v205
    s_waitcnt lgkmcnt(1)
    v_mfma_f32_16x16x32_bf16 v[88:91], v[16:19], v[176:179], v[88:91]
    ds_read_b128 v[12:15], v2 offset:10240
    v_perm_b32 v200, v204, v248, s56
    v_perm_b32 v201, v204, v248, s57
    v_mfma_f32_16x16x32_bf16 v[92:95], v[16:19], v[180:183], v[92:95]
    v_perm_b32 v250, v7, v6, v205
    v_perm_b32 v205, v11, v10, v205
    v_xor_b32 v250, v202, v250
    s_waitcnt lgkmcnt(1)
    v_mfma_f32_16x16x32_bf16 v[80:83], v[20:23], v[184:187], v[80:83]
    ds_read_b128 v[16:19], v1 offset:12288
    v_perm_b32 v204, v25, v24, v206
    v_xor_b32_e64 v205, v203, v205
    v_mfma_f32_16x16x32_bf16 v[84:87], v[20:23], v[188:191], v[84:87]
    v_perm_b32 v202, v205, v250, s56
    v_perm_b32 v203, v205, v250, s57
    s_waitcnt lgkmcnt(1)
    v_mfma_f32_16x16x32_bf16 v[88:91], v[12:15], v[184:187], v[88:91]
    ds_read_b128 v[20:23], v1 offset:14336
    v_perm_b32 v205, v29, v28, v206
    v_perm_b32 v255, v29, v28, v207
    v_mfma_f32_16x16x32_bf16 v[92:95], v[12:15], v[188:191], v[92:95]
    v_xor_b32 v206, s58, v206
    v_perm_b32 v252, v27, v26, v206
    v_xor_b32 v252, v204, v252
    s_waitcnt lgkmcnt(1)
    v_mfma_f32_16x16x32_bf16 v[96:99], v[16:19], v[176:179], v[96:99]
    ds_read_b128 v[12:15], v2 offset:12288
    v_perm_b32 v206, v31, v30, v206
    v_xor_b32_e64 v206, v205, v206
    v_mfma_f32_16x16x32_bf16 v[100:103], v[16:19], v[180:183], v[100:103]
    v_perm_b32 v204, v206, v252, s56
    v_perm_b32 v205, v206, v252, s57
    s_waitcnt lgkmcnt(1)
    v_mfma_f32_16x16x32_bf16 v[104:107], v[20:23], v[176:179], v[104:107]
    ds_read_b128 v[16:19], v2 offset:14336
    v_perm_b32 v206, v25, v24, v207
    v_xor_b32 v207, s58, v207
    v_mfma_f32_16x16x32_bf16 v[108:111], v[20:23], v[180:183], v[108:111]
    v_perm_b32 v254, v27, v26, v207
    v_perm_b32 v207, v31, v30, v207
    v_xor_b32 v254, v206, v254
    s_waitcnt lgkmcnt(1)
    v_mfma_f32_16x16x32_bf16 v[96:99], v[12:15], v[184:187], v[96:99]
    s_barrier
    ds_read_b128 v[212:215], v3 offset:0
L_t13:
    s_cbranch_vccnz L_tret
    ds_read_b128 v[220:223], v3 offset:4096
    ds_read_b128 v[20:23], v1 offset:16384
    v_xor_b32_e64 v207, v255, v207
    v_perm_b32 v206, v207, v254, s56
    v_mfma_f32_16x16x32_bf16 v[100:103], v[12:15], v[188:191], v[100:103]
    v_perm_b32 v207, v207, v254, s57
    s_waitcnt lgkmcnt(3)
    v_mfma_f32_16x16x32_bf16 v[104:107], v[16:19], v[184:187], v[104:107]
    ds_read_b128 v[12:15], v1 offset:18432
    v_mfma_f32_16x16x32_bf16 v[108:111], v[16:19], v[188:191], v[108:111]
    s_waitcnt lgkmcnt(3)
    v_perm_b32 v208, v5, v4, v212
    v_perm_b32 v209, v9, v8, v212
    v_xor_b32 v212, s58, v212
    s_waitcnt lgkmcnt(1)
    v_mfma_f32_16x16x32_bf16 v[48:51], v[20:23], v[192:195], v[48:51]
    ds_read_b128 v[16:19], v2 offset:16384
    v_perm_b32 v240, v7, v6, v212
    v_perm_b32 v212, v11, v10, v212
    v_mfma_f32_16x16x32_bf16 v[52:55], v[20:23], v[196:199], v[52:55]
    v_perm_b32 v210, v5, v4, v213
    v_perm_b32 v211, v9, v8, v213
    v_xor_b32 v240, v208, v240
    s_waitcnt lgkmcnt(1)
    v_mfma_f32_16x16x32_bf16 v[56:59], v[12:15], v[192:195], v[56:59]
    ds_read_b128 v[20:23], v2 offset:18432
    v_xor_b32_e64 v212, v209, v212
    v_perm_b32 v208, v212, v240, s56
    v_mfma_f32_16x16x32_bf16 v[60:63], v[12:15], v[196:199], v[60:63]
    v_perm_b32 v209, v212, v240, s57
    v_perm_b32 v212, v25, v24, v214
    v_xor_b32 v213, s58, v213
    s_waitcnt lgkmcnt(1)
    v_mfma_f32_16x16x32_bf16 v[48:51], v[16:19], v[200:203], v[48:51]
    ds_read_b128 v[12:15], v1 offset:20480
    v_perm_b32 v242, v7, v6, v213
    v_perm_b32 v213, v11, v10, v213
    v_mfma_f32_16x16x32_bf16 v[52:55], v[16:19], v[204:207], v[52:55]
    v_xor_b32_e64 v242, v210, v242
    v_xor_b32_e64 v213, v211, v213
    s_waitcnt lgkmcnt(1)
    v_mfma_f32_16x16x32_bf16 v[56:59], v[20:23], v[200:203], v[56:59]
    ds_read_b128 v[16:19], v1 offset:22528
    v_perm_b32 v210, v213, v242, s56
    v_perm_b32 v211, v213, v242, s57
    v_mfma_f32_16x16x32_bf16 v[60:63], v[20:23], v[204:207], v[60:63]
    v_perm_b32 v213, v29, v28, v214
    v_perm_b32 v247, v29, v28, v215
    v_xor_b32 v214, s58, v214
    s_waitcnt lgkmcnt(1)
    v_mfma_f32_16x16x32_bf16 v[64:67], v[12:15], v[192:195], v[64:67]
    ds_read_b128 v[20:23], v2 offset:20480
    v_perm_b32 v244, v27, v26, v214
    v_perm_b32 v214, v31, v30, v214
    v_mfma_f32_16x16x32_bf16 v[68:71], v[12:15], v[196:199], v[68:71]
    v_xor_b32 v244, v212, v244
    v_xor_b32_e64 v214, v213, v214
    s_waitcnt lgkmcnt(1)
    v_mfma_f32_16x16x32_bf16 v[72:75], v[16:19], v[192:195], v[72:75]
    ds_read_b128 v[12:15], v2 offset:22528
    v_perm_b32 v212, v214, v244, s56
    v_perm_b32 v213, v214, v244, s57
    v_mfma_f32_16x16x32_bf16 v[76:79], v[16:19], v[196:199], v[76:79]
    v_perm_b32 v214, v25, v24, v215
    v_perm_b32 v216, v5, v4, v220
    v_perm_b32 v217, v9, v8, v220
    s_waitcnt lgkmcnt(1)
    v_mfma_f32_16x16x32_bf16 v[64:67], v[20:23], v[200:203], v[64:67]
    ds_read_b128 v[16:19], v1 offset:24576
    v_xor_b32_e64 v215, s58, v215
    v_perm_b32 v246, v27, v26, v215
    v_mfma_f32_16x16x32_bf16 v[68:71], v[20:23], v[204:207], v[68:71]
    v_perm_b32 v215, v31, v30, v215
    v_xor_b32_e64 v246, v214, v246
    v_xor_b32 v215, v247, v215
    s_waitcnt lgkmcnt(1)
    v_mfma_f32_16x16x32_bf16 v[72:75], v[12:15], v[200:203], v[72:75]
    ds_read_b128 v[20:23], v1 offset:26624
    v_perm_b32 v214, v215, v246, s56
    v_perm_b32 v215, v215, v246, s57
    v_mfma_f32_16x16x32_bf16 v[76:79], v[12:15], v[204:207], v[76:79]
    v_perm_b32 v218, v5, v4, v221
    v_perm_b32 v219, v9, v8, v221
    v_xor_b32 v220, s58, v220
    s_waitcnt lgkmcnt(1)
    v_mfma_f32_16x16x32_bf16 v[80:83], v[16:19], v[192:195], v[80:83]
    ds_read_b128 v[12:15], v2 offset:24576
    v_perm_b32 v248, v7, v6, v220
    v_perm_b32 v220, v11, v10, v220
    v_mfma_f32_16x16x32_bf16 v[84:87], v[16:19], v[196:199], v[84:87]
    v_xor_b32_e64 v248, v216, v248
    v_xor_b32_e64 v220, v217, v220
    v_xor_b32 v221, s58, v221
    s_waitcnt lgkmcnt(1)
    v_mfma_f32_16x16x32_bf16 v[88:91], v[20:23], v[192:195], v[88:91]
    ds_read_b128 v[16:19], v2 offset:26624
    v_perm_b32 v216, v220, v248, s56
    v_perm_b32 v217, v220, v248, s57
    v_mfma_f32_16x16x32_bf16 v[92:95], v[20:23], v[196:199], v[92:95]
    v_perm_b32 v250, v7, v6, v221
    v_perm_b32 v221, v11, v10, v221
    v_xor_b32 v250, v218, v250
    s_waitcnt lgkmcnt(1)
    v_mfma_f32_16x16x32_bf16 v[80:83], v[12:15], v[200:203], v[80:83]
    ds_read_b128 v[20:23], v1 offset:28672
    v_perm_b32 v220, v25, v24, v222
    v_xor_b32_e64 v221, v219, v221
    v_mfma_f32_16x16x32_bf16 v[84:87], v[12:15], v[204:207], v[84:87]
    v_perm_b32 v218, v221, v250, s56
    v_perm_b32 v219, v221, v250, s57
    s_waitcnt lgkmcnt(1)
    v_mfma_f32_16x16x32_bf16 v[88:91], v[16:19], v[200:203], v[88:91]
    ds_read_b128 v[12:15], v1 offset:30720
    v_perm_b32 v221, v29, v28, v222
    v_perm_b32 v255, v29, v28, v223
    v_mfma_f32_16x16x32_bf16 v[92:95], v[16:19], v[204:207], v[92:95]
    v_xor_b32 v222, s58, v222
    v_perm_b32 v252, v27, v26, v222
    v_xor_b32 v252, v220, v252
    s_waitcnt lgkmcnt(1)
    v_mfma_f32_16x16x32_bf16 v[96:99], v[20:23], v[192:195], v[96:99]
    ds_read_b128 v[16:19], v2 offset:28672
    v_perm_b32 v222, v31, v30, v222
    v_xor_b32_e64 v222, v221, v222
    v_mfma_f32_16x16x32_bf16 v[100:103], v[20:23], v[196:199], v[100:103]
    v_perm_b32 v220, v222, v252, s56
    v_perm_b32 v221, v222, v252, s57
    s_waitcnt lgkmcnt(1)
    v_mfma_f32_16x16x32_bf16 v[104:107], v[12:15], v[192:195], v[104:107]
    ds_read_b128 v[20:23], v2 offset:30720
    v_perm_b32 v222, v25, v24, v223
    v_xor_b32 v223, s58, v223
    v_mfma_f32_16x16x32_bf16 v[108:111], v[12:15], v[196:199], v[108:111]
    v_perm_b32 v254, v27, v26, v223
    v_perm_b32 v223, v31, v30, v223
    v_xor_b32 v254, v222, v254
    s_waitcnt lgkmcnt(1)
    v_mfma_f32_16x16x32_bf16 v[96:99], v[16:19], v[200:203], v[96:99]
    s_barrier
    ds_read_b128 v[228:231], v3 offset:8192
    ds_read_b128 v[236:239], v3 offset:12288
    ds_read_b128 v[12:15], v1 offset:32768
    v_xor_b32 v223, v255, v223
L_t14:
    s_cbranch_vccnz L_tret
    v_perm_b32 v222, v223, v254, s56
    v_mfma_f32_16x16x32_bf16 v[100:103], v[16:19], v[204:207], v[100:103]
    v_perm_b32 v223, v223, v254, s57
    s_waitcnt lgkmcnt(3)
    v_mfma_f32_16x16x32_bf16 v[104:107], v[20:23], v[200:203], v[104:107]
    ds_read_b128 v[16:19], v1 offset:34816
    v_mfma_f32_16x16x32_bf16 v[108:111], v[20:23], v[204:207], v[108:111]
    s_waitcnt lgkmcnt(3)
    v_perm_b32 v224, v5, v4, v228
    v_perm_b32 v225, v9, v8, v228
    v_perm_b32 v226, v5, v4, v229
    s_waitcnt lgkmcnt(1)
    v_mfma_f32_16x16x32_bf16 v[48:51], v[12:15], v[208:211], v[48:51]
    ds_read_b128 v[20:23], v2 offset:32768
    v_perm_b32 v227, v9, v8, v229
    v_mfma_f32_16x16x32_bf16 v[52:55], v[12:15], v[212:215], v[52:55]
    v_xor_b32 v228, s58, v228
    s_waitcnt lgkmcnt(1)
    v_mfma_f32_16x16x32_bf16 v[56:59], v[16:19], v[208:211], v[56:59]
    ds_read_b128 v[12:15], v2 offset:34816
    v_perm_b32 v240, v7, v6, v228
    v_perm_b32 v228, v11, v10, v228
    v_mfma_f32_16x16x32_bf16 v[60:63], v[16:19], v[212:215], v[60:63]
    v_xor_b32_e64 v240, v224, v240
    v_xor_b32_e64 v228, v225, v228
    v_xor_b32 v229, s58, v229
    s_waitcnt lgkmcnt(1)
    v_mfma_f32_16x16x32_bf16 v[48:51], v[20:23], v[216:219], v[48:51]
    ds_read_b128 v[16:19], v1 offset:36864
    v_perm_b32 v224, v228, v240, s56
    v_mfma_f32_16x16x32_bf16 v[52:55], v[20:23], v[220:223], v[52:55]
    v_perm_b32 v225, v228, v240, s57
    s_waitcnt lgkmcnt(1)
    v_mfma_f32_16x16x32_bf16 v[56:59], v[12:15], v[216:219], v[56:59]
    ds_read_b128 v[20:23], v1 offset:38912
    v_perm_b32 v242, v7, v6, v229
    v_perm_b32 v229, v11, v10, v229
    v_mfma_f32_16x16x32_bf16 v[60:63], v[12:15], v[220:223], v[60:63]
    v_perm_b32 v228, v25, v24, v230
    v_xor_b32 v242, v226, v242
    v_xor_b32 v229, v227, v229
    s_waitcnt lgkmcnt(1)
    v_mfma_f32_16x16x32_bf16 v[64:67], v[16:19], v[208:211], v[64:67]
    ds_read_b128 v[12:15], v2 offset:36864
    v_perm_b32 v226, v229, v242, s56
    v_mfma_f32_16x16x32_bf16 v[68:71], v[16:19], v[212:215], v[68:71]
    v_perm_b32 v227, v229, v242, s57
    s_waitcnt lgkmcnt(1)
    v_mfma_f32_16x16x32_bf16 v[72:75], v[20:23], v[208:211], v[72:75]
    ds_read_b128 v[16:19], v2 offset:38912
    v_perm_b32 v229, v29, v28, v230
    v_perm_b32 v247, v29, v28, v231
    v_mfma_f32_16x16x32_bf16 v[76:79], v[20:23], v[212:215], v[76:79]
    v_xor_b32 v230, s58, v230
    v_perm_b32 v244, v27, v26, v230
    v_xor_b32 v244, v228, v244
    s_waitcnt lgkmcnt(1)
    v_mfma_f32_16x16x32_bf16 v[64:67], v[12:15], v[216:219], v[64:67]
    ds_read_b128 v[20:23], v1 offset:40960
    v_perm_b32 v230, v31, v30, v230
    v_mfma_f32_16x16x32_bf16 v[68:71], v[12:15], v[220:223], v[68:71]
    v_xor_b32 v230, v229, v230
    s_waitcnt lgkmcnt(1)
    v_mfma_f32_16x16x32_bf16 v[72:75], v[16:19], v[216:219], v[72:75]
    ds_read_b128 v[12:15], v1 offset:43008
    v_perm_b32 v228, v230, v244, s56
    v_perm_b32 v229, v230, v244, s57
    v_mfma_f32_16x16x32_bf16 v[76:79], v[16:19], v[220:223], v[76:79]
    v_perm_b32 v230, v25, v24, v231
    v_perm_b32 v232, v5, v4, v236
    v_xor_b32 v231, s58, v231
    s_waitcnt lgkmcnt(1)
    v_mfma_f32_16x16x32_bf16 v[80:83], v[20:23], v[208:211], v[80:83]
    ds_read_b128 v[16:19], v2 offset:40960
    v_perm_b32 v246, v27, v26, v231
    v_mfma_f32_16x16x32_bf16 v[84:87], v[20:23], v[212:215], v[84:87]
    v_xor_b32 v246, v230, v246
    s_waitcnt lgkmcnt(1)
    v_mfma_f32_16x16x32_bf16 v[88:91], v[12:15], v[208:211], v[88:91]
    ds_read_b128 v[20:23], v2 offset:43008
    v_perm_b32 v231, v31, v30, v231
    v_perm_b32 v233, v9, v8, v236
    v_mfma_f32_16x16x32_bf16 v[92:95], v[12:15], v[212:215], v[92:95]
    v_xor_b32_e64 v231, v247, v231
    v_perm_b32 v230, v231, v246, s56
    v_xor_b32 v236, s58, v236
    s_waitcnt lgkmcnt(1)
    v_mfma_f32_16x16x32_bf16 v[80:83], v[16:19], v[216:219], v[80:83]
    ds_read_b128 v[12:15], v1 offset:45056
    v_perm_b32 v231, v231, v246, s57
    v_mfma_f32_16x16x32_bf16 v[84:87], v[16:19], v[220:223], v[84:87]
    v_perm_b32 v248, v7, v6, v236
    s_waitcnt lgkmcnt(1)
    v_mfma_f32_16x16x32_bf16 v[88:91], v[20:23], v[216:219], v[88:91]
    ds_read_b128 v[16:19], v1 offset:47104
    v_perm_b32 v236, v11, v10, v236
    v_perm_b32 v234, v5, v4, v237
    v_mfma_f32_16x16x32_bf16 v[92:95], v[20:23], v[220:223], v[92:95]
    v_perm_b32 v235, v9, v8, v237
    v_xor_b32 v248, v232, v248
    v_xor_b32 v236, v233, v236
    s_waitcnt lgkmcnt(1)
    v_mfma_f32_16x16x32_bf16 v[96:99], v[12:15], v[208:211], v[96:99]
    ds_read_b128 v[20:23], v2 offset:45056
    v_perm_b32 v232, v236, v248, s56
    v_mfma_f32_16x16x32_bf16 v[100:103], v[12:15], v[212:215], v[100:103]
    v_xor_b32 v237, s58, v237
    s_waitcnt lgkmcnt(1)
    v_mfma_f32_16x16x32_bf16 v[104:107], v[16:19], v[208:211], v[104:107]
    ds_read_b128 v[12:15], v2 offset:47104
    v_perm_b32 v233, v236, v248, s57
    v_perm_b32 v250, v7, v6, v237
    v_mfma_f32_16x16x32_bf16 v[108:111], v[16:19], v[212:215], v[108:111]
    v_perm_b32 v237, v11, v10, v237
    v_perm_b32 v236, v25, v24, v238
    v_xor_b32 v250, v234, v250
    s_waitcnt lgkmcnt(1)
    v_mfma_f32_16x16x32_bf16 v[96:99], v[20:23], v[216:219], v[96:99]
    ds_read_b128 v[16:19], v1 offset:49152
    v_xor_b32_e64 v237, v235, v237
    v_mfma_f32_16x16x32_bf16 v[100:103], v[20:23], v[220:223], v[100:103]
    v_perm_b32 v234, v237, v250, s56
    s_waitcnt lgkmcnt(1)
    v_mfma_f32_16x16x32_bf16 v[104:107], v[12:15], v[216:219], v[104:107]
    ds_read_b128 v[20:23], v1 offset:51200
    v_perm_b32 v235, v237, v250, s57
    v_perm_b32 v237, v29, v28, v238
    v_mfma_f32_16x16x32_bf16 v[108:111], v[12:15], v[220:223], v[108:111]
    v_perm_b32 v255, v29, v28, v239
    v_xor_b32 v238, s58, v238
    v_perm_b32 v252, v27, v26, v238
    s_waitcnt lgkmcnt(1)
    v_mfma_f32_16x16x32_bf16 v[32:35], v[16:19], v[112:115], 0
    ds_read_b128 v[12:15], v2 offset:49152
    v_perm_b32 v238, v31, v30, v238
    v_mfma_f32_16x16x32_bf16 v[36:39], v[16:19], v[116:119], 0
    v_xor_b32 v252, v236, v252
    s_waitcnt lgkmcnt(1)
    v_mfma_f32_16x16x32_bf16 v[40:43], v[20:23], v[112:115], 0
    ds_read_b128 v[16:19], v2 offset:51200
    v_xor_b32 v238, v237, v238
    v_perm_b32 v236, v238, v252, s56
    v_mfma_f32_16x16x32_bf16 v[44:47], v[20:23], v[116:119], 0
    v_perm_b32 v237, v238, v252, s57
    v_perm_b32 v238, v25, v24, v239
    v_xor_b32 v239, s58, v239
    s_waitcnt lgkmcnt(1)
L_t15:
    s_cbranch_vccnz L_tret
    v_mfma_f32_16x16x32_bf16 v[32:35], v[12:15], v[120:123], v[32:35]
    ds_read_b128 v[20:23], v1 offset:53248
    v_perm_b32 v254, v27, v26, v239
    v_mfma_f32_16x16x32_bf16 v[36:39], v[12:15], v[124:127], v[36:39]
    v_perm_b32 v239, v31, v30, v239
    s_waitcnt lgkmcnt(1)
    v_mfma_f32_16x16x32_bf16 v[40:43], v[16:19], v[120:123], v[40:43]
    ds_read_b128 v[12:15], v1 offset:55296
    v_xor_b32_e64 v254, v238, v254
    v_xor_b32_e64 v239, v255, v239
    v_mfma_f32_16x16x32_bf16 v[44:47], v[16:19], v[124:127], v[44:47]
    v_perm_b32 v238, v239, v254, s56
    v_perm_b32 v239, v239, v254, s57
    s_waitcnt lgkmcnt(1)
    v_mfma_f32_16x16x32_bf16 v[32:35], v[20:23], v[128:131], v[32:35]
    ds_read_b128 v[16:19], v2 offset:53248
    v_mfma_f32_16x16x32_bf16 v[36:39], v[20:23], v[132:135], v[36:39]
    s_waitcnt lgkmcnt(1)
    v_mfma_f32_16x16x32_bf16 v[40:43], v[12:15], v[128:131], v[40:43]
    ds_read_b128 v[20:23], v2 offset:55296
    v_mfma_f32_16x16x32_bf16 v[44:47], v[12:15], v[132:135], v[44:47]
    s_waitcnt lgkmcnt(1)
    v_mfma_f32_16x16x32_bf16 v[32:35], v[16:19], v[136:139], v[32:35]
    s_barrier
    ds_read_b128 v[12:15], v1 offset:57344
    v_mfma_f32_16x16x32_bf16 v[36:39], v[16:19], v[140:143], v[36:39]
    s_waitcnt lgkmcnt(1)
    v_mfma_f32_16x16x32_bf16 v[40:43], v[20:23], v[136:139], v[40:43]
    ds_read_b128 v[16:19], v1 offset:59392
    v_mfma_f32_16x16x32_bf16 v[44:47], v[20:23], v[140:143], v[44:47]
    s_waitcnt lgkmcnt(1)
    v_mfma_f32_16x16x32_bf16 v[32:35], v[12:15], v[144:147], v[32:35]
    ds_read_b128 v[20:23], v2 offset:57344
    v_mfma_f32_16x16x32_bf16 v[36:39], v[12:15], v[148:151], v[36:39]
    s_waitcnt lgkmcnt(1)
    v_mfma_f32_16x16x32_bf16 v[40:43], v[16:19], v[144:147], v[40:43]
    ds_read_b128 v[12:15], v2 offset:59392
    v_mfma_f32_16x16x32_bf16 v[44:47], v[16:19], v[148:151], v[44:47]
    s_waitcnt lgkmcnt(1)
    v_mfma_f32_16x16x32_bf16 v[32:35], v[20:23], v[152:155], v[32:35]
    ds_read_b128 v[16:19], v1 offset:61440
    v_mfma_f32_16x16x32_bf16 v[36:39], v[20:23], v[156:159], v[36:39]
    s_waitcnt lgkmcnt(1)
    v_mfma_f32_16x16x32_bf16 v[40:43], v[12:15], v[152:155], v[40:43]
    ds_read_b128 v[20:23], v1 offset:63488
    v_mfma_f32_16x16x32_bf16 v[44:47], v[12:15], v[156:159], v[44:47]
    s_waitcnt lgkmcnt(1)
    v_mfma_f32_16x16x32_bf16 v[32:35], v[16:19], v[160:163], v[32:35]
    ds_read_b128 v[12:15], v2 offset:61440
    v_mfma_f32_16x16x32_bf16 v[36:39], v[16:19], v[164:167], v[36:39]
    s_waitcnt lgkmcnt(1)
    v_mfma_f32_16x16x32_bf16 v[40:43], v[20:23], v[160:163], v[40:43]
    ds_read_b128 v[16:19], v2 offset:63488
    v_mfma_f32_16x16x32_bf16 v[44:47], v[20:23], v[164:167], v[44:47]
    s_waitcnt lgkmcnt(1)
    v_mfma_f32_16x16x32_bf16 v[32:35], v[12:15], v[168:171], v[32:35]
    v_add_u32 v1, s59, v1
    v_add_u32 v2, s59, v2
    ds_read_b128 v[20:23], v1 offset:0
    v_mfma_f32_16x16x32_bf16 v[36:39], v[12:15], v[172:175], v[36:39]
    s_waitcnt lgkmcnt(1)
    v_mfma_f32_16x16x32_bf16 v[40:43], v[16:19], v[168:171], v[40:43]
    ds_read_b128 v[12:15], v1 offset:2048
    v_mfma_f32_16x16x32_bf16 v[44:47], v[16:19], v[172:175], v[44:47]
    s_waitcnt lgkmcnt(1)
    v_mfma_f32_16x16x32_bf16 v[48:51], v[20:23], v[224:227], v[48:51]
    ds_read_b128 v[16:19], v2 offset:0
    v_mfma_f32_16x16x32_bf16 v[52:55], v[20:23], v[228:231], v[52:55]
    s_waitcnt lgkmcnt(1)
    v_mfma_f32_16x16x32_bf16 v[56:59], v[12:15], v[224:227], v[56:59]
    ds_read_b128 v[20:23], v2 offset:2048
    v_mfma_f32_16x16x32_bf16 v[60:63], v[12:15], v[228:231], v[60:63]
    s_waitcnt lgkmcnt(1)
    v_mfma_f32_16x16x32_bf16 v[48:51], v[16:19], v[232:235], v[48:51]
    s_barrier
    ds_read_b128 v[244:247], v3 offset:0
    ds_read_b128 v[252:255], v3 offset:4096
    ds_read_b128 v[12:15], v1 offset:4096
    v_mfma_f32_16x16x32_bf16 v[52:55], v[16:19], v[236:239], v[52:55]
    s_waitcnt lgkmcnt(3)
    v_mfma_f32_16x16x32_bf16 v[56:59], v[20:23], v[232:235], v[56:59]
    ds_read_b128 v[16:19], v1 offset:6144
    v_mfma_f32_16x16x32_bf16 v[60:63], v[20:23], v[236:239], v[60:63]
    s_waitcnt lgkmcnt(3)
    v_perm_b32 v240, v5, v4, v244
    v_perm_b32 v241, v9, v8, v244
    v_perm_b32 v242, v5, v4, v245
    s_waitcnt lgkmcnt(1)
    v_mfma_f32_16x16x32_bf16 v[64:67], v[12:15], v[224:227], v[64:67]
    ds_read_b128 v[20:23], v2 offset:4096
    v_perm_b32 v243, v9, v8, v245
    v_mfma_f32_16x16x32_bf16 v[68:71], v[12:15], v[228:231], v[68:71]
    v_xor_b32 v244, s58, v244
    s_waitcnt lgkmcnt(1)
    v_mfma_f32_16x16x32_bf16 v[72:75], v[16:19], v[224:227], v[72:75]
    ds_read_b128 v[12:15], v2 offset:6144
    v_perm_b32 v248, v7, v6, v244
    v_perm_b32 v244, v11, v10, v244
    v_mfma_f32_16x16x32_bf16 v[76:79], v[16:19], v[228:231], v[76:79]
    v_xor_b32_e64 v248, v240, v248
    v_xor_b32_e64 v244, v241, v244
    v_xor_b32 v245, s58, v245
    s_waitcnt lgkmcnt(1)
    v_mfma_f32_16x16x32_bf16 v[64:67], v[20:23], v[232:235], v[64:67]
    ds_read_b128 v[16:19], v1 offset:8192
    v_perm_b32 v240, v244, v248, s56
    v_mfma_f32_16x16x32_bf16 v[68:71], v[20:23], v[236:239], v[68:71]
    v_perm_b32 v241, v244, v248, s57
    s_waitcnt lgkmcnt(1)
    v_mfma_f32_16x16x32_bf16 v[72:75], v[12:15], v[232:235], v[72:75]
    ds_read_b128 v[20:23], v1 offset:10240
    v_perm_b32 v249, v7, v6, v245
    v_perm_b32 v245, v11, v10, v245
    v_mfma_f32_16x16x32_bf16 v[76:79], v[12:15], v[236:239], v[76:79]
    v_perm_b32 v244, v25, v24, v246
    v_xor_b32 v249, v242, v249
    v_xor_b32 v245, v243, v245
    s_waitcnt lgkmcnt(1)
    v_mfma_f32_16x16x32_bf16 v[80:83], v[16:19], v[224:227], v[80:83]
    ds_read_b128 v[12:15], v2 offset:8192
    v_perm_b32 v242, v245, v249, s56
    v_mfma_f32_16x16x32_bf16 v[84:87], v[16:19], v[228:231], v[84:87]
    v_perm_b32 v243, v245, v249, s57
    s_waitcnt lgkmcnt(1)
    v_mfma_f32_16x16x32_bf16 v[88:91], v[20:23], v[224:227], v[88:91]
    ds_read_b128 v[16:19], v2 offset:10240
    v_perm_b32 v245, v29, v28, v246
    v_perm_b32 v248, v29, v28, v247
    v_mfma_f32_16x16x32_bf16 v[92:95], v[20:23], v[228:231], v[92:95]
    v_xor_b32 v246, s58, v246
    v_perm_b32 v250, v27, v26, v246
    v_xor_b32 v250, v244, v250
    s_waitcnt lgkmcnt(1)
    v_mfma_f32_16x16x32_bf16 v[80:83], v[12:15], v[232:235], v[80:83]
    ds_read_b128 v[20:23], v1 offset:12288
    v_perm_b32 v246, v31, v30, v246
    v_mfma_f32_16x16x32_bf16 v[84:87], v[12:15], v[236:239], v[84:87]
    v_xor_b32 v246, v245, v246
    s_waitcnt lgkmcnt(1)
    v_mfma_f32_16x16x32_bf16 v[88:91], v[16:19], v[232:235], v[88:91]
    ds_read_b128 v[12:15], v1 offset:14336
    v_perm_b32 v244, v246, v250, s56
    v_perm_b32 v245, v246, v250, s57
    v_mfma_f32_16x16x32_bf16 v[92:95], v[16:19], v[236:239], v[92:95]
    v_perm_b32 v246, v25, v24, v247
    v_perm_b32 v249, v9, v8, v252
L_t16:
    s_cbranch_vccnz L_tret
    v_xor_b32 v247, s58, v247
    s_waitcnt lgkmcnt(1)
    v_mfma_f32_16x16x32_bf16 v[96:99], v[20:23], v[224:227], v[96:99]
    ds_read_b128 v[16:19], v2 offset:12288
    v_perm_b32 v251, v27, v26, v247
    v_mfma_f32_16x16x32_bf16 v[100:103], v[20:23], v[228:231], v[100:103]
    v_perm_b32 v247, v31, v30, v247
    s_waitcnt lgkmcnt(1)
    v_mfma_f32_16x16x32_bf16 v[104:107], v[12:15], v[224:227], v[104:107]
    ds_read_b128 v[20:23], v2 offset:14336
    v_xor_b32_e64 v251, v246, v251
    v_xor_b32_e64 v247, v248, v247
    v_mfma_f32_16x16x32_bf16 v[108:111], v[12:15], v[228:231], v[108:111]
    v_perm_b32 v246, v247, v251, s56
    v_perm_b32 v247, v247, v251, s57
    v_perm_b32 v248, v5, v4, v252
    s_waitcnt lgkmcnt(1)
    v_mfma_f32_16x16x32_bf16 v[96:99], v[16:19], v[232:235], v[96:99]
    v_add_u32 v1, s64, v1
    v_add_u32 v2, s64, v2
    ds_read_b128 v[12:15], v1 offset:0
    v_perm_b32 v251, v9, v8, v253
    v_mfma_f32_16x16x32_bf16 v[100:103], v[16:19], v[236:239], v[100:103]
    v_xor_b32 v252, s58, v252
    s_waitcnt lgkmcnt(1)
    v_mfma_f32_16x16x32_bf16 v[104:107], v[20:23], v[232:235], v[104:107]
    ds_read_b128 v[16:19], v1 offset:2048
    v_perm_b32 v250, v7, v6, v252
    v_perm_b32 v252, v11, v10, v252
    v_mfma_f32_16x16x32_bf16 v[108:111], v[20:23], v[236:239], v[108:111]
    v_xor_b32 v250, v248, v250
    v_xor_b32_e64 v252, v249, v252
    v_perm_b32 v248, v252, v250, s56
    s_waitcnt lgkmcnt(1)
    v_mfma_f32_16x16x32_bf16 v[32:35], v[12:15], v[176:179], v[32:35]
    ds_read_b128 v[20:23], v2 offset:0
    v_perm_b32 v249, v252, v250, s57
    v_mfma_f32_16x16x32_bf16 v[36:39], v[12:15], v[180:183], v[36:39]
    v_perm_b32 v250, v5, v4, v253
    s_waitcnt lgkmcnt(1)
    v_mfma_f32_16x16x32_bf16 v[40:43], v[16:19], v[176:179], v[40:43]
    ds_read_b128 v[12:15], v2 offset:2048
    v_xor_b32_e64 v253, s58, v253
    v_perm_b32 v252, v7, v6, v253
    v_mfma_f32_16x16x32_bf16 v[44:47], v[16:19], v[180:183], v[44:47]
    v_perm_b32 v253, v11, v10, v253
    v_xor_b32_e64 v252, v250, v252
    v_xor_b32 v253, v251, v253
    s_waitcnt lgkmcnt(1)
    v_mfma_f32_16x16x32_bf16 v[32:35], v[20:23], v[184:187], v[32:35]
    ds_read_b128 v[16:19], v1 offset:4096
    v_perm_b32 v250, v253, v252, s56
    v_mfma_f32_16x16x32_bf16 v[36:39], v[20:23], v[188:191], v[36:39]
    v_perm_b32 v251, v253, v252, s57
    s_waitcnt lgkmcnt(1)
    v_mfma_f32_16x16x32_bf16 v[40:43], v[12:15], v[184:187], v[40:43]
    ds_read_b128 v[20:23], v1 offset:6144
    v_perm_b32 v252, v25, v24, v254
    v_perm_b32 v253, v29, v28, v254
    v_mfma_f32_16x16x32_bf16 v[44:47], v[12:15], v[188:191], v[44:47]
    v_perm_b32 v6, v29, v28, v255
    v_xor_b32 v254, s58, v254
    v_perm_b32 v4, v27, v26, v254
    s_waitcnt lgkmcnt(1)
    v_mfma_f32_16x16x32_bf16 v[32:35], v[16:19], v[192:195], v[32:35]
    ds_read_b128 v[12:15], v2 offset:4096
    v_perm_b32 v254, v31, v30, v254
    v_mfma_f32_16x16x32_bf16 v[36:39], v[16:19], v[196:199], v[36:39]
    v_xor_b32 v4, v252, v4
    s_waitcnt lgkmcnt(1)
    v_mfma_f32_16x16x32_bf16 v[40:43], v[20:23], v[192:195], v[40:43]
    ds_read_b128 v[16:19], v2 offset:6144
    v_xor_b32 v254, v253, v254
    v_perm_b32 v252, v254, v4, s56
    v_mfma_f32_16x16x32_bf16 v[44:47], v[20:23], v[196:199], v[44:47]
    v_perm_b32 v253, v254, v4, s57
    v_perm_b32 v254, v25, v24, v255
    v_xor_b32 v255, s58, v255
    s_waitcnt lgkmcnt(1)
    v_mfma_f32_16x16x32_bf16 v[32:35], v[12:15], v[200:203], v[32:35]
    s_barrier
    ds_read_b128 v[20:23], v1 offset:8192
    v_perm_b32 v5, v27, v26, v255
    v_mfma_f32_16x16x32_bf16 v[36:39], v[12:15], v[204:207], v[36:39]
    v_perm_b32 v255, v31, v30, v255
    s_waitcnt lgkmcnt(1)
    v_mfma_f32_16x16x32_bf16 v[40:43], v[16:19], v[200:203], v[40:43]
    ds_read_b128 v[12:15], v1 offset:10240
    v_xor_b32_e64 v5, v254, v5
    v_xor_b32_e64 v255, v6, v255
    v_mfma_f32_16x16x32_bf16 v[44:47], v[16:19], v[204:207], v[44:47]
    v_perm_b32 v254, v255, v5, s56
    v_perm_b32 v255, v255, v5, s57
    v_add_u32 v4, s62, v0
    s_waitcnt lgkmcnt(1)
    v_mfma_f32_16x16x32_bf16 v[32:35], v[20:23], v[208:211], v[32:35]
    ds_read_b128 v[16:19], v2 offset:8192
    v_add_u32_e64 v5, s62, v4
    v_mfma_f32_16x16x32_bf16 v[36:39], v[20:23], v[212:215], v[36:39]
    v_add_u32 v6, s62, v5
    s_waitcnt lgkmcnt(1)
    v_mfma_f32_16x16x32_bf16 v[40:43], v[12:15], v[208:211], v[40:43]
    ds_read_b128 v[20:23], v2 offset:10240
    v_mfma_f32_16x16x32_bf16 v[44:47], v[12:15], v[212:215], v[44:47]
    s_waitcnt lgkmcnt(1)
    v_mfma_f32_16x16x32_bf16 v[32:35], v[16:19], v[216:219], v[32:35]
    ds_read_b128 v[12:15], v1 offset:12288
    v_mfma_f32_16x16x32_bf16 v[36:39], v[16:19], v[220:223], v[36:39]
    s_waitcnt lgkmcnt(1)
    v_mfma_f32_16x16x32_bf16 v[40:43], v[20:23], v[216:219], v[40:43]
    ds_read_b128 v[16:19], v1 offset:14336
    v_mfma_f32_16x16x32_bf16 v[44:47], v[20:23], v[220:223], v[44:47]
    s_waitcnt lgkmcnt(1)
    v_mfma_f32_16x16x32_bf16 v[32:35], v[12:15], v[224:227], v[32:35]
    ds_read_b128 v[20:23], v2 offset:12288
    v_mfma_f32_16x16x32_bf16 v[36:39], v[12:15], v[228:231], v[36:39]
    s_waitcnt lgkmcnt(1)
    v_mfma_f32_16x16x32_bf16 v[40:43], v[16:19], v[224:227], v[40:43]
    ds_read_b128 v[12:15], v2 offset:14336
    v_mfma_f32_16x16x32_bf16 v[44:47], v[16:19], v[228:231], v[44:47]
    s_waitcnt lgkmcnt(1)
    v_mfma_f32_16x16x32_bf16 v[32:35], v[20:23], v[232:235], v[32:35]
    ds_read_b128 v[16:19], v1 offset:16384
    v_mfma_f32_16x16x32_bf16 v[36:39], v[20:23], v[236:239], v[36:39]
    s_waitcnt lgkmcnt(1)
    v_mfma_f32_16x16x32_bf16 v[40:43], v[12:15], v[232:235], v[40:43]
    ds_read_b128 v[20:23], v1 offset:18432
    v_mfma_f32_16x16x32_bf16 v[44:47], v[12:15], v[236:239], v[44:47]
    s_waitcnt lgkmcnt(1)
    v_mfma_f32_16x16x32_bf16 v[48:51], v[16:19], v[240:243], v[48:51]
    ds_read_b128 v[12:15], v2 offset:16384
    v_mfma_f32_16x16x32_bf16 v[52:55], v[16:19], v[244:247], v[52:55]
    s_waitcnt lgkmcnt(1)
    v_mfma_f32_16x16x32_bf16 v[56:59], v[20:23], v[240:243], v[56:59]
    ds_read_b128 v[16:19], v2 offset:18432
    v_mfma_f32_16x16x32_bf16 v[60:63], v[20:23], v[244:247], v[60:63]
    s_waitcnt lgkmcnt(1)
    v_mfma_f32_16x16x32_bf16 v[48:51], v[12:15], v[248:251], v[48:51]
    ds_read_b128 v[20:23], v1 offset:20480
    v_mfma_f32_16x16x32_bf16 v[52:55], v[12:15], v[252:255], v[52:55]
    s_waitcnt lgkmcnt(1)
    v_mfma_f32_16x16x32_bf16 v[56:59], v[16:19], v[248:251], v[56:59]
    ds_read_b128 v[12:15], v1 offset:22528
    v_mfma_f32_16x16x32_bf16 v[60:63], v[16:19], v[252:255], v[60:63]
    s_waitcnt lgkmcnt(1)
    v_mfma_f32_16x16x32_bf16 v[64:67], v[20:23], v[240:243], v[64:67]
    ds_read_b128 v[16:19], v2 offset:20480
L_t17:
    s_cbranch_vccnz L_tret
    v_mfma_f32_16x16x32_bf16 v[68:71], v[20:23], v[244:247], v[68:71]
    s_waitcnt lgkmcnt(1)
    v_mfma_f32_16x16x32_bf16 v[72:75], v[12:15], v[240:243], v[72:75]
    ds_read_b128 v[20:23], v2 offset:22528
    v_cvt_pk_bf16_f32 v48, v48, v52
    v_mfma_f32_16x16x32_bf16 v[76:79], v[12:15], v[244:247], v[76:79]
    v_cvt_pk_bf16_f32 v49, v49, v53
    s_waitcnt lgkmcnt(1)
    v_mfma_f32_16x16x32_bf16 v[64:67], v[16:19], v[248:251], v[64:67]
    ds_read_b128 v[12:15], v1 offset:24576
    v_cvt_pk_bf16_f32 v50, v50, v54
    v_mfma_f32_16x16x32_bf16 v[68:71], v[16:19], v[252:255], v[68:71]
    v_cvt_pk_bf16_f32 v51, v51, v55
    s_waitcnt lgkmcnt(1)
    v_mfma_f32_16x16x32_bf16 v[72:75], v[20:23], v[248:251], v[72:75]
    ds_read_b128 v[16:19], v1 offset:26624
    v_cvt_pk_bf16_f32 v56, v56, v60
    v_mfma_f32_16x16x32_bf16 v[76:79], v[20:23], v[252:255], v[76:79]
    v_cvt_pk_bf16_f32 v57, v57, v61
    s_waitcnt lgkmcnt(1)
    v_mfma_f32_16x16x32_bf16 v[80:83], v[12:15], v[240:243], v[80:83]
    ds_read_b128 v[20:23], v2 offset:24576
    v_cvt_pk_bf16_f32 v58, v58, v62
    v_mfma_f32_16x16x32_bf16 v[84:87], v[12:15], v[244:247], v[84:87]
    v_cvt_pk_bf16_f32 v59, v59, v63
    s_waitcnt lgkmcnt(1)
    v_mfma_f32_16x16x32_bf16 v[88:91], v[16:19], v[240:243], v[88:91]
    ds_read_b128 v[12:15], v2 offset:26624
    v_cvt_pk_bf16_f32 v64, v64, v68
    v_mfma_f32_16x16x32_bf16 v[92:95], v[16:19], v[244:247], v[92:95]
    v_cvt_pk_bf16_f32 v65, v65, v69
    s_waitcnt lgkmcnt(1)
    v_mfma_f32_16x16x32_bf16 v[80:83], v[20:23], v[248:251], v[80:83]
    s_barrier
    ds_read_b128 v[16:19], v1 offset:28672
    v_cvt_pk_bf16_f32 v66, v66, v70
    v_mfma_f32_16x16x32_bf16 v[84:87], v[20:23], v[252:255], v[84:87]
    v_cvt_pk_bf16_f32 v67, v67, v71
    s_waitcnt lgkmcnt(1)
    v_mfma_f32_16x16x32_bf16 v[88:91], v[12:15], v[248:251], v[88:91]
    ds_read_b128 v[20:23], v1 offset:30720
    v_cvt_pk_bf16_f32 v72, v72, v76
    v_mfma_f32_16x16x32_bf16 v[92:95], v[12:15], v[252:255], v[92:95]
    v_cvt_pk_bf16_f32 v73, v73, v77
    s_waitcnt lgkmcnt(1)
    v_mfma_f32_16x16x32_bf16 v[96:99], v[16:19], v[240:243], v[96:99]
    ds_read_b128 v[12:15], v2 offset:28672
    v_cvt_pk_bf16_f32 v74, v74, v78
    v_mfma_f32_16x16x32_bf16 v[100:103], v[16:19], v[244:247], v[100:103]
    v_cvt_pk_bf16_f32 v75, v75, v79
    s_waitcnt lgkmcnt(1)
    v_mfma_f32_16x16x32_bf16 v[104:107], v[20:23], v[240:243], v[104:107]
    ds_read_b128 v[16:19], v2 offset:30720
    v_cvt_pk_bf16_f32 v80, v80, v84
    v_mfma_f32_16x16x32_bf16 v[108:111], v[20:23], v[244:247], v[108:111]
    v_cvt_pk_bf16_f32 v81, v81, v85
    s_waitcnt lgkmcnt(1)
    v_mfma_f32_16x16x32_bf16 v[96:99], v[12:15], v[248:251], v[96:99]
    ds_read_b128 v[20:23], v1 offset:32768
    v_cvt_pk_bf16_f32 v82, v82, v86
    v_mfma_f32_16x16x32_bf16 v[100:103], v[12:15], v[252:255], v[100:103]
    v_cvt_pk_bf16_f32 v83, v83, v87
    s_waitcnt lgkmcnt(1)
    v_mfma_f32_16x16x32_bf16 v[104:107], v[16:19], v[248:251], v[104:107]
    ds_read_b128 v[12:15], v1 offset:34816
    v_cvt_pk_bf16_f32 v88, v88, v92
    v_mfma_f32_16x16x32_bf16 v[108:111], v[16:19], v[252:255], v[108:111]
    v_cvt_pk_bf16_f32 v89, v89, v93
    s_waitcnt lgkmcnt(1)
    v_mfma_f32_16x16x32_bf16 v[32:35], v[20:23], v[240:243], v[32:35]
    ds_read_b128 v[16:19], v2 offset:32768
    v_cvt_pk_bf16_f32 v90, v90, v94
    v_mfma_f32_16x16x32_bf16 v[36:39], v[20:23], v[244:247], v[36:39]
    v_cvt_pk_bf16_f32 v91, v91, v95
    s_waitcnt lgkmcnt(1)
    v_mfma_f32_16x16x32_bf16 v[40:43], v[12:15], v[240:243], v[40:43]
    ds_read_b128 v[20:23], v2 offset:34816
    v_cvt_pk_bf16_f32 v96, v96, v100
    v_mfma_f32_16x16x32_bf16 v[44:47], v[12:15], v[244:247], v[44:47]
    v_cvt_pk_bf16_f32 v97, v97, v101
    s_waitcnt lgkmcnt(1)
    v_mfma_f32_16x16x32_bf16 v[32:35], v[16:19], v[248:251], v[32:35]
    ds_read_b128 v[12:15], v1 offset:36864
    v_cvt_pk_bf16_f32 v98, v98, v102
    v_mfma_f32_16x16x32_bf16 v[36:39], v[16:19], v[252:255], v[36:39]
    v_cvt_pk_bf16_f32 v99, v99, v103
    s_waitcnt lgkmcnt(1)
    v_mfma_f32_16x16x32_bf16 v[40:43], v[20:23], v[248:251], v[40:43]
    ds_read_b128 v[16:19], v1 offset:38912
    v_cvt_pk_bf16_f32 v104, v104, v108
    v_mfma_f32_16x16x32_bf16 v[44:47], v[20:23], v[252:255], v[44:47]
    v_cvt_pk_bf16_f32 v105, v105, v109
    s_waitcnt lgkmcnt(1)
    v_mfma_f32_16x16x32_bf16 v[24:27], v[12:15], v[112:115], 0
    ds_read_b128 v[20:23], v2 offset:36864
    v_cvt_pk_bf16_f32 v106, v106, v110
    v_mfma_f32_16x16x32_bf16 v[28:31], v[12:15], v[116:119], 0
    v_cvt_pk_bf16_f32 v107, v107, v111
    s_waitcnt lgkmcnt(1)
    v_mfma_f32_16x16x32_bf16 v[8:11], v[16:19], v[112:115], 0
    ds_read_b128 v[12:15], v2 offset:38912
    v_cvt_pk_bf16_f32 v32, v32, v36
    v_mfma_f32_16x16x32_bf16 v[52:55], v[16:19], v[116:119], 0
    v_cvt_pk_bf16_f32 v33, v33, v37
    s_waitcnt lgkmcnt(1)
    v_mfma_f32_16x16x32_bf16 v[24:27], v[20:23], v[120:123], v[24:27]
    ds_read_b128 v[16:19], v1 offset:40960
    v_cvt_pk_bf16_f32 v34, v34, v38
    v_mfma_f32_16x16x32_bf16 v[28:31], v[20:23], v[124:127], v[28:31]
    v_cvt_pk_bf16_f32 v35, v35, v39
    s_waitcnt lgkmcnt(1)
    v_mfma_f32_16x16x32_bf16 v[8:11], v[12:15], v[120:123], v[8:11]
    ds_read_b128 v[20:23], v1 offset:43008
    v_cvt_pk_bf16_f32 v40, v40, v44
    v_mfma_f32_16x16x32_bf16 v[52:55], v[12:15], v[124:127], v[52:55]
    v_cvt_pk_bf16_f32 v41, v41, v45
    s_waitcnt lgkmcnt(1)
    v_mfma_f32_16x16x32_bf16 v[24:27], v[16:19], v[128:131], v[24:27]
    ds_read_b128 v[12:15], v2 offset:40960
    buffer_store_dword v48, v0, s[12:15], s80 offen sc1
    v_mfma_f32_16x16x32_bf16 v[28:31], v[16:19], v[132:135], v[28:31]
    v_cvt_pk_bf16_f32 v42, v42, v46
    s_waitcnt lgkmcnt(1)
    v_mfma_f32_16x16x32_bf16 v[8:11], v[20:23], v[128:131], v[8:11]
    ds_read_b128 v[16:19], v2 offset:43008
    v_cvt_pk_bf16_f32 v43, v43, v47
    v_mfma_f32_16x16x32_bf16 v[52:55], v[20:23], v[132:135], v[52:55]
    s_waitcnt lgkmcnt(1)
    v_mfma_f32_16x16x32_bf16 v[24:27], v[12:15], v[136:139], v[24:27]
    ds_read_b128 v[20:23], v1 offset:45056
    v_mfma_f32_16x16x32_bf16 v[28:31], v[12:15], v[140:143], v[28:31]
    s_waitcnt lgkmcnt(1)
    v_mfma_f32_16x16x32_bf16 v[8:11], v[16:19], v[136:139], v[8:11]
    ds_read_b128 v[12:15], v1 offset:47104
    buffer_store_dword v49, v4, s[12:15], s80 offen sc1
    v_mfma_f32_16x16x32_bf16 v[52:55], v[16:19], v[140:143], v[52:55]
    s_waitcnt lgkmcnt(1)
    v_mfma_f32_16x16x32_bf16 v[24:27], v[20:23], v[144:147], v[24:27]
    ds_read_b128 v[16:19], v2 offset:45056
    v_mfma_f32_16x16x32_bf16 v[28:31], v[20:23], v[148:151], v[28:31]
L_t18:
    s_cbranch_vccnz L_tret
    s_waitcnt lgkmcnt(1)
    v_mfma_f32_16x16x32_bf16 v[8:11], v[12:15], v[144:147], v[8:11]
    ds_read_b128 v[20:23], v2 offset:47104
    v_mfma_f32_16x16x32_bf16 v[52:55], v[12:15], v[148:151], v[52:55]
    s_waitcnt lgkmcnt(1)
    v_mfma_f32_16x16x32_bf16 v[24:27], v[16:19], v[152:155], v[24:27]
    ds_read_b128 v[12:15], v1 offset:49152
    buffer_store_dword v50, v5, s[12:15], s80 offen sc1
    v_mfma_f32_16x16x32_bf16 v[28:31], v[16:19], v[156:159], v[28:31]
    s_waitcnt lgkmcnt(1)
    v_mfma_f32_16x16x32_bf16 v[8:11], v[20:23], v[152:155], v[8:11]
    ds_read_b128 v[16:19], v1 offset:51200
    v_mfma_f32_16x16x32_bf16 v[52:55], v[20:23], v[156:159], v[52:55]
    s_waitcnt lgkmcnt(1)
    v_mfma_f32_16x16x32_bf16 v[24:27], v[12:15], v[160:163], v[24:27]
    ds_read_b128 v[20:23], v2 offset:49152
    v_mfma_f32_16x16x32_bf16 v[28:31], v[12:15], v[164:167], v[28:31]
    s_waitcnt lgkmcnt(1)
    v_mfma_f32_16x16x32_bf16 v[8:11], v[16:19], v[160:163], v[8:11]
    ds_read_b128 v[12:15], v2 offset:51200
    buffer_store_dword v51, v6, s[12:15], s80 offen sc1
    v_mfma_f32_16x16x32_bf16 v[52:55], v[16:19], v[164:167], v[52:55]
    s_waitcnt lgkmcnt(1)
    v_mfma_f32_16x16x32_bf16 v[24:27], v[20:23], v[168:171], v[24:27]
    ds_read_b128 v[16:19], v1 offset:53248
    v_mfma_f32_16x16x32_bf16 v[28:31], v[20:23], v[172:175], v[28:31]
    s_waitcnt lgkmcnt(1)
    v_mfma_f32_16x16x32_bf16 v[8:11], v[12:15], v[168:171], v[8:11]
    ds_read_b128 v[20:23], v1 offset:55296
    v_mfma_f32_16x16x32_bf16 v[52:55], v[12:15], v[172:175], v[52:55]
    s_waitcnt lgkmcnt(1)
    v_mfma_f32_16x16x32_bf16 v[24:27], v[16:19], v[176:179], v[24:27]
    ds_read_b128 v[12:15], v2 offset:53248
    buffer_store_dword v56, v0, s[12:15], s81 offen sc1
    v_mfma_f32_16x16x32_bf16 v[28:31], v[16:19], v[180:183], v[28:31]
    s_waitcnt lgkmcnt(1)
    v_mfma_f32_16x16x32_bf16 v[8:11], v[20:23], v[176:179], v[8:11]
    ds_read_b128 v[16:19], v2 offset:55296
    v_mfma_f32_16x16x32_bf16 v[52:55], v[20:23], v[180:183], v[52:55]
    s_waitcnt lgkmcnt(1)
    v_mfma_f32_16x16x32_bf16 v[24:27], v[12:15], v[184:187], v[24:27]
    s_barrier
    ds_read_b128 v[20:23], v1 offset:57344
    v_mfma_f32_16x16x32_bf16 v[28:31], v[12:15], v[188:191], v[28:31]
    s_waitcnt lgkmcnt(1)
    v_mfma_f32_16x16x32_bf16 v[8:11], v[16:19], v[184:187], v[8:11]
    ds_read_b128 v[12:15], v1 offset:59392
    buffer_store_dword v57, v4, s[12:15], s81 offen sc1
    v_mfma_f32_16x16x32_bf16 v[52:55], v[16:19], v[188:191], v[52:55]
    s_waitcnt lgkmcnt(1)
    v_mfma_f32_16x16x32_bf16 v[24:27], v[20:23], v[192:195], v[24:27]
    ds_read_b128 v[16:19], v2 offset:57344
    v_mfma_f32_16x16x32_bf16 v[28:31], v[20:23], v[196:199], v[28:31]
    s_waitcnt lgkmcnt(1)
    v_mfma_f32_16x16x32_bf16 v[8:11], v[12:15], v[192:195], v[8:11]
    ds_read_b128 v[20:23], v2 offset:59392
    v_mfma_f32_16x16x32_bf16 v[52:55], v[12:15], v[196:199], v[52:55]
    s_waitcnt lgkmcnt(1)
    v_mfma_f32_16x16x32_bf16 v[24:27], v[16:19], v[200:203], v[24:27]
    ds_read_b128 v[12:15], v1 offset:61440
    buffer_store_dword v58, v5, s[12:15], s81 offen sc1
    v_mfma_f32_16x16x32_bf16 v[28:31], v[16:19], v[204:207], v[28:31]
    s_waitcnt lgkmcnt(1)
    v_mfma_f32_16x16x32_bf16 v[8:11], v[20:23], v[200:203], v[8:11]
    ds_read_b128 v[16:19], v1 offset:63488
    v_mfma_f32_16x16x32_bf16 v[52:55], v[20:23], v[204:207], v[52:55]
    s_waitcnt lgkmcnt(1)
    v_mfma_f32_16x16x32_bf16 v[24:27], v[12:15], v[208:211], v[24:27]
    ds_read_b128 v[20:23], v2 offset:61440
    v_mfma_f32_16x16x32_bf16 v[28:31], v[12:15], v[212:215], v[28:31]
    s_waitcnt lgkmcnt(1)
    v_mfma_f32_16x16x32_bf16 v[8:11], v[16:19], v[208:211], v[8:11]
    ds_read_b128 v[12:15], v2 offset:63488
    buffer_store_dword v59, v6, s[12:15], s81 offen sc1
    v_mfma_f32_16x16x32_bf16 v[52:55], v[16:19], v[212:215], v[52:55]
    s_waitcnt lgkmcnt(1)
    v_mfma_f32_16x16x32_bf16 v[24:27], v[20:23], v[216:219], v[24:27]
    v_add_u32 v1, s59, v1
    v_add_u32 v2, s59, v2
    ds_read_b128 v[16:19], v1 offset:0
    v_mfma_f32_16x16x32_bf16 v[28:31], v[20:23], v[220:223], v[28:31]
    s_waitcnt lgkmcnt(1)
    v_mfma_f32_16x16x32_bf16 v[8:11], v[12:15], v[216:219], v[8:11]
    ds_read_b128 v[20:23], v1 offset:2048
    v_mfma_f32_16x16x32_bf16 v[52:55], v[12:15], v[220:223], v[52:55]
    s_waitcnt lgkmcnt(1)
    v_mfma_f32_16x16x32_bf16 v[24:27], v[16:19], v[224:227], v[24:27]
    ds_read_b128 v[12:15], v2 offset:0
    buffer_store_dword v64, v0, s[12:15], s82 offen sc1
    v_mfma_f32_16x16x32_bf16 v[28:31], v[16:19], v[228:231], v[28:31]
    s_waitcnt lgkmcnt(1)
    v_mfma_f32_16x16x32_bf16 v[8:11], v[20:23], v[224:227], v[8:11]
    ds_read_b128 v[16:19], v2 offset:2048
    v_mfma_f32_16x16x32_bf16 v[52:55], v[20:23], v[228:231], v[52:55]
    s_waitcnt lgkmcnt(1)
    v_mfma_f32_16x16x32_bf16 v[24:27], v[12:15], v[232:235], v[24:27]
    ds_read_b128 v[20:23], v1 offset:4096
    v_mfma_f32_16x16x32_bf16 v[28:31], v[12:15], v[236:239], v[28:31]
    s_waitcnt lgkmcnt(1)
    v_mfma_f32_16x16x32_bf16 v[8:11], v[16:19], v[232:235], v[8:11]
    ds_read_b128 v[12:15], v1 offset:6144
    buffer_store_dword v65, v4, s[12:15], s82 offen sc1
    v_mfma_f32_16x16x32_bf16 v[52:55], v[16:19], v[236:239], v[52:55]
    s_waitcnt lgkmcnt(1)
    v_mfma_f32_16x16x32_bf16 v[24:27], v[20:23], v[240:243], v[24:27]
    ds_read_b128 v[16:19], v2 offset:4096
    v_mfma_f32_16x16x32_bf16 v[28:31], v[20:23], v[244:247], v[28:31]
    s_waitcnt lgkmcnt(1)
    v_mfma_f32_16x16x32_bf16 v[8:11], v[12:15], v[240:243], v[8:11]
    ds_read_b128 v[20:23], v2 offset:6144
    v_mfma_f32_16x16x32_bf16 v[52:55], v[12:15], v[244:247], v[52:55]
    s_waitcnt lgkmcnt(1)
    v_mfma_f32_16x16x32_bf16 v[24:27], v[16:19], v[248:251], v[24:27]
    ds_read_b128 v[12:15], v1 offset:8192
    buffer_store_dword v66, v5, s[12:15], s82 offen sc1
    v_mfma_f32_16x16x32_bf16 v[28:31], v[16:19], v[252:255], v[28:31]
    s_waitcnt lgkmcnt(1)
    v_mfma_f32_16x16x32_bf16 v[8:11], v[20:23], v[248:251], v[8:11]
    ds_read_b128 v[16:19], v1 offset:10240
    v_mfma_f32_16x16x32_bf16 v[52:55], v[20:23], v[252:255], v[52:55]
    s_waitcnt lgkmcnt(1)
    v_mfma_f32_16x16x32_bf16 v[60:63], v[12:15], v[112:115], 0
    ds_read_b128 v[20:23], v2 offset:8192
    v_mfma_f32_16x16x32_bf16 v[68:71], v[12:15], v[116:119], 0
    s_waitcnt lgkmcnt(1)
    v_mfma_f32_16x16x32_bf16 v[76:79], v[16:19], v[112:115], 0
    ds_read_b128 v[12:15], v2 offset:10240
    buffer_store_dword v67, v6, s[12:15], s82 offen sc1
    v_mfma_f32_16x16x32_bf16 v[84:87], v[16:19], v[116:119], 0
    v_cvt_pk_bf16_f32 v24, v24, v28
    s_waitcnt lgkmcnt(1)
    v_mfma_f32_16x16x32_bf16 v[60:63], v[20:23], v[120:123], v[60:63]
    ds_read_b128 v[16:19], v1 offset:12288
    v_cvt_pk_bf16_f32 v25, v25, v29
    v_mfma_f32_16x16x32_bf16 v[68:71], v[20:23], v[124:127], v[68:71]
    v_cvt_pk_bf16_f32 v26, v26, v30
    s_waitcnt lgkmcnt(1)
    v_mfma_f32_16x16x32_bf16 v[76:79], v[12:15], v[120:123], v[76:79]
    ds_read_b128 v[20:23], v1 offset:14336
    v_cvt_pk_bf16_f32 v27, v27, v31
    v_mfma_f32_16x16x32_bf16 v[84:87], v[12:15], v[124:127], v[84:87]
    v_cvt_pk_bf16_f32 v8, v8, v52
    s_waitcnt lgkmcnt(1)
    v_mfma_f32_16x16x32_bf16 v[60:63], v[16:19], v[128:131], v[60:63]
    ds_read_b128 v[12:15], v2 offset:12288
L_t19:
    s_cbranch_vccnz L_tret
    buffer_store_dword v72, v0, s[12:15], s83 offen sc1
    v_mfma_f32_16x16x32_bf16 v[68:71], v[16:19], v[132:135], v[68:71]
    v_cvt_pk_bf16_f32 v9, v9, v53
    s_waitcnt lgkmcnt(1)
    v_mfma_f32_16x16x32_bf16 v[76:79], v[20:23], v[128:131], v[76:79]
    ds_read_b128 v[16:19], v2 offset:14336
    v_cvt_pk_bf16_f32 v10, v10, v54
    v_mfma_f32_16x16x32_bf16 v[84:87], v[20:23], v[132:135], v[84:87]
    v_cvt_pk_bf16_f32 v11, v11, v55
    s_waitcnt lgkmcnt(1)
    v_mfma_f32_16x16x32_bf16 v[60:63], v[12:15], v[136:139], v[60:63]
    ds_read_b128 v[20:23], v1 offset:16384
    v_mfma_f32_16x16x32_bf16 v[68:71], v[12:15], v[140:143], v[68:71]
    s_waitcnt lgkmcnt(1)
    v_mfma_f32_16x16x32_bf16 v[76:79], v[16:19], v[136:139], v[76:79]
    ds_read_b128 v[12:15], v1 offset:18432
    buffer_store_dword v73, v4, s[12:15], s83 offen sc1
    v_mfma_f32_16x16x32_bf16 v[84:87], v[16:19], v[140:143], v[84:87]
    s_waitcnt lgkmcnt(1)
    v_mfma_f32_16x16x32_bf16 v[60:63], v[20:23], v[144:147], v[60:63]
    ds_read_b128 v[16:19], v2 offset:16384
    v_mfma_f32_16x16x32_bf16 v[68:71], v[20:23], v[148:151], v[68:71]
    s_waitcnt lgkmcnt(1)
    v_mfma_f32_16x16x32_bf16 v[76:79], v[12:15], v[144:147], v[76:79]
    ds_read_b128 v[20:23], v2 offset:18432
    v_mfma_f32_16x16x32_bf16 v[84:87], v[12:15], v[148:151], v[84:87]
    s_waitcnt lgkmcnt(1)
    v_mfma_f32_16x16x32_bf16 v[60:63], v[16:19], v[152:155], v[60:63]
    s_barrier
    ds_read_b128 v[12:15], v1 offset:20480
    buffer_store_dword v74, v5, s[12:15], s83 offen sc1
    v_mfma_f32_16x16x32_bf16 v[68:71], v[16:19], v[156:159], v[68:71]
    s_waitcnt lgkmcnt(1)
    v_mfma_f32_16x16x32_bf16 v[76:79], v[20:23], v[152:155], v[76:79]
    ds_read_b128 v[16:19], v1 offset:22528
    v_mfma_f32_16x16x32_bf16 v[84:87], v[20:23], v[156:159], v[84:87]
    s_waitcnt lgkmcnt(1)
    v_mfma_f32_16x16x32_bf16 v[60:63], v[12:15], v[160:163], v[60:63]
    ds_read_b128 v[20:23], v2 offset:20480
    v_mfma_f32_16x16x32_bf16 v[68:71], v[12:15], v[164:167], v[68:71]
    s_waitcnt lgkmcnt(1)
    v_mfma_f32_16x16x32_bf16 v[76:79], v[16:19], v[160:163], v[76:79]
    ds_read_b128 v[12:15], v2 offset:22528
    buffer_store_dword v75, v6, s[12:15], s83 offen sc1
    v_mfma_f32_16x16x32_bf16 v[84:87], v[16:19], v[164:167], v[84:87]
    s_waitcnt lgkmcnt(1)
    v_mfma_f32_16x16x32_bf16 v[60:63], v[20:23], v[168:171], v[60:63]
    ds_read_b128 v[16:19], v1 offset:24576
    v_mfma_f32_16x16x32_bf16 v[68:71], v[20:23], v[172:175], v[68:71]
    s_waitcnt lgkmcnt(1)
    v_mfma_f32_16x16x32_bf16 v[76:79], v[12:15], v[168:171], v[76:79]
    ds_read_b128 v[20:23], v1 offset:26624
    v_mfma_f32_16x16x32_bf16 v[84:87], v[12:15], v[172:175], v[84:87]
    s_waitcnt lgkmcnt(1)
    v_mfma_f32_16x16x32_bf16 v[60:63], v[16:19], v[176:179], v[60:63]
    ds_read_b128 v[12:15], v2 offset:24576
    buffer_store_dword v80, v0, s[12:15], s84 offen sc1
    v_mfma_f32_16x16x32_bf16 v[68:71], v[16:19], v[180:183], v[68:71]
    s_waitcnt lgkmcnt(1)
    v_mfma_f32_16x16x32_bf16 v[76:79], v[20:23], v[176:179], v[76:79]
    ds_read_b128 v[16:19], v2 offset:26624
    v_mfma_f32_16x16x32_bf16 v[84:87], v[20:23], v[180:183], v[84:87]
    s_waitcnt lgkmcnt(1)
    v_mfma_f32_16x16x32_bf16 v[60:63], v[12:15], v[184:187], v[60:63]
    ds_read_b128 v[20:23], v1 offset:28672
    buffer_store_dword v81, v4, s[12:15], s84 offen sc1
    v_mfma_f32_16x16x32_bf16 v[68:71], v[12:15], v[188:191], v[68:71]
    s_waitcnt lgkmcnt(1)
    v_mfma_f32_16x16x32_bf16 v[76:79], v[16:19], v[184:187], v[76:79]
    ds_read_b128 v[12:15], v1 offset:30720
    v_mfma_f32_16x16x32_bf16 v[84:87], v[16:19], v[188:191], v[84:87]
    s_waitcnt lgkmcnt(1)
    v_mfma_f32_16x16x32_bf16 v[60:63], v[20:23], v[192:195], v[60:63]
    ds_read_b128 v[16:19], v2 offset:28672
    buffer_store_dword v82, v5, s[12:15], s84 offen sc1
    v_mfma_f32_16x16x32_bf16 v[68:71], v[20:23], v[196:199], v[68:71]
    s_waitcnt lgkmcnt(1)
    v_mfma_f32_16x16x32_bf16 v[76:79], v[12:15], v[192:195], v[76:79]
    ds_read_b128 v[20:23], v2 offset:30720
    v_mfma_f32_16x16x32_bf16 v[84:87], v[12:15], v[196:199], v[84:87]
    s_waitcnt lgkmcnt(1)
    v_mfma_f32_16x16x32_bf16 v[60:63], v[16:19], v[200:203], v[60:63]
    ds_read_b128 v[12:15], v1 offset:32768
    buffer_store_dword v83, v6, s[12:15], s84 offen sc1
    v_mfma_f32_16x16x32_bf16 v[68:71], v[16:19], v[204:207], v[68:71]
    s_waitcnt lgkmcnt(1)
    v_mfma_f32_16x16x32_bf16 v[76:79], v[20:23], v[200:203], v[76:79]
    ds_read_b128 v[16:19], v1 offset:34816
    v_mfma_f32_16x16x32_bf16 v[84:87], v[20:23], v[204:207], v[84:87]
    s_waitcnt lgkmcnt(1)
    v_mfma_f32_16x16x32_bf16 v[60:63], v[12:15], v[208:211], v[60:63]
    ds_read_b128 v[20:23], v2 offset:32768
    buffer_store_dword v88, v0, s[12:15], s85 offen sc1
    v_mfma_f32_16x16x32_bf16 v[68:71], v[12:15], v[212:215], v[68:71]
    s_waitcnt lgkmcnt(1)
    v_mfma_f32_16x16x32_bf16 v[76:79], v[16:19], v[208:211], v[76:79]
    ds_read_b128 v[12:15], v2 offset:34816
    v_mfma_f32_16x16x32_bf16 v[84:87], v[16:19], v[212:215], v[84:87]
    s_waitcnt lgkmcnt(1)
    v_mfma_f32_16x16x32_bf16 v[60:63], v[20:23], v[216:219], v[60:63]
    ds_read_b128 v[16:19], v1 offset:36864
    buffer_store_dword v89, v4, s[12:15], s85 offen sc1
    v_mfma_f32_16x16x32_bf16 v[68:71], v[20:23], v[220:223], v[68:71]
    s_waitcnt lgkmcnt(1)
    v_mfma_f32_16x16x32_bf16 v[76:79], v[12:15], v[216:219], v[76:79]
    ds_read_b128 v[20:23], v1 offset:38912
    v_mfma_f32_16x16x32_bf16 v[84:87], v[12:15], v[220:223], v[84:87]
    s_waitcnt lgkmcnt(1)
    v_mfma_f32_16x16x32_bf16 v[60:63], v[16:19], v[224:227], v[60:63]
    ds_read_b128 v[12:15], v2 offset:36864
    buffer_store_dword v90, v5, s[12:15], s85 offen sc1
    v_mfma_f32_16x16x32_bf16 v[68:71], v[16:19], v[228:231], v[68:71]
    s_waitcnt lgkmcnt(1)
    v_mfma_f32_16x16x32_bf16 v[76:79], v[20:23], v[224:227], v[76:79]
    ds_read_b128 v[16:19], v2 offset:38912
    v_mfma_f32_16x16x32_bf16 v[84:87], v[20:23], v[228:231], v[84:87]
    s_waitcnt lgkmcnt(1)
    v_mfma_f32_16x16x32_bf16 v[60:63], v[12:15], v[232:235], v[60:63]
    ds_read_b128 v[20:23], v1 offset:40960
    buffer_store_dword v91, v6, s[12:15], s85 offen sc1
    v_mfma_f32_16x16x32_bf16 v[68:71], v[12:15], v[236:239], v[68:71]
    s_waitcnt lgkmcnt(1)
    v_mfma_f32_16x16x32_bf16 v[76:79], v[16:19], v[232:235], v[76:79]
    ds_read_b128 v[12:15], v1 offset:43008
    v_mfma_f32_16x16x32_bf16 v[84:87], v[16:19], v[236:239], v[84:87]
    s_waitcnt lgkmcnt(1)
    v_mfma_f32_16x16x32_bf16 v[60:63], v[20:23], v[240:243], v[60:63]
    ds_read_b128 v[16:19], v2 offset:40960
    buffer_store_dword v96, v0, s[12:15], s86 offen sc1
    v_mfma_f32_16x16x32_bf16 v[68:71], v[20:23], v[244:247], v[68:71]
    s_waitcnt lgkmcnt(1)
    v_mfma_f32_16x16x32_bf16 v[76:79], v[12:15], v[240:243], v[76:79]
    ds_read_b128 v[20:23], v2 offset:43008
    v_mfma_f32_16x16x32_bf16 v[84:87], v[12:15], v[244:247], v[84:87]
    s_waitcnt lgkmcnt(1)
    v_mfma_f32_16x16x32_bf16 v[60:63], v[16:19], v[248:251], v[60:63]
    ds_read_b128 v[12:15], v1 offset:45056
    buffer_store_dword v97, v4, s[12:15], s86 offen sc1
    v_mfma_f32_16x16x32_bf16 v[68:71], v[16:19], v[252:255], v[68:71]
    s_waitcnt lgkmcnt(1)
    v_mfma_f32_16x16x32_bf16 v[76:79], v[20:23], v[248:251], v[76:79]
    ds_read_b128 v[16:19], v1 offset:47104
    v_mfma_f32_16x16x32_bf16 v[84:87], v[20:23], v[252:255], v[84:87]
L_t20:
    s_cbranch_vccnz L_tret
    s_waitcnt lgkmcnt(1)
    v_mfma_f32_16x16x32_bf16 v[92:95], v[12:15], v[112:115], 0
    ds_read_b128 v[20:23], v2 offset:45056
    buffer_store_dword v98, v5, s[12:15], s86 offen sc1
    v_mfma_f32_16x16x32_bf16 v[100:103], v[12:15], v[116:119], 0
    v_cvt_pk_bf16_f32 v60, v60, v68
    s_waitcnt lgkmcnt(1)
    v_mfma_f32_16x16x32_bf16 v[108:111], v[16:19], v[112:115], 0
    ds_read_b128 v[12:15], v2 offset:47104
    v_cvt_pk_bf16_f32 v61, v61, v69
    v_mfma_f32_16x16x32_bf16 v[36:39], v[16:19], v[116:119], 0
    v_cvt_pk_bf16_f32 v62, v62, v70
    s_waitcnt lgkmcnt(1)
    v_mfma_f32_16x16x32_bf16 v[92:95], v[20:23], v[120:123], v[92:95]
    ds_read_b128 v[16:19], v1 offset:49152
    buffer_store_dword v99, v6, s[12:15], s86 offen sc1
    v_mfma_f32_16x16x32_bf16 v[100:103], v[20:23], v[124:127], v[100:103]
    v_cvt_pk_bf16_f32 v63, v63, v71
    s_waitcnt lgkmcnt(1)
    v_mfma_f32_16x16x32_bf16 v[108:111], v[12:15], v[120:123], v[108:111]
    ds_read_b128 v[20:23], v1 offset:51200
    v_cvt_pk_bf16_f32 v76, v76, v84
    v_mfma_f32_16x16x32_bf16 v[36:39], v[12:15], v[124:127], v[36:39]
    v_cvt_pk_bf16_f32 v77, v77, v85
    s_waitcnt lgkmcnt(1)
    v_mfma_f32_16x16x32_bf16 v[92:95], v[16:19], v[128:131], v[92:95]
    ds_read_b128 v[12:15], v2 offset:49152
    buffer_store_dword v104, v0, s[12:15], s87 offen sc1
    v_mfma_f32_16x16x32_bf16 v[100:103], v[16:19], v[132:135], v[100:103]
    v_cvt_pk_bf16_f32 v78, v78, v86
    s_waitcnt lgkmcnt(1)
    v_mfma_f32_16x16x32_bf16 v[108:111], v[20:23], v[128:131], v[108:111]
    ds_read_b128 v[16:19], v2 offset:51200
    v_cvt_pk_bf16_f32 v79, v79, v87
    v_mfma_f32_16x16x32_bf16 v[36:39], v[20:23], v[132:135], v[36:39]
    s_waitcnt lgkmcnt(1)
    v_mfma_f32_16x16x32_bf16 v[92:95], v[12:15], v[136:139], v[92:95]
    ds_read_b128 v[20:23], v1 offset:53248
    buffer_store_dword v105, v4, s[12:15], s87 offen sc1
    v_mfma_f32_16x16x32_bf16 v[100:103], v[12:15], v[140:143], v[100:103]
    s_waitcnt lgkmcnt(1)
    v_mfma_f32_16x16x32_bf16 v[108:111], v[16:19], v[136:139], v[108:111]
    ds_read_b128 v[12:15], v1 offset:55296
    v_mfma_f32_16x16x32_bf16 v[36:39], v[16:19], v[140:143], v[36:39]
    s_waitcnt lgkmcnt(1)
    v_mfma_f32_16x16x32_bf16 v[92:95], v[20:23], v[144:147], v[92:95]
    ds_read_b128 v[16:19], v2 offset:53248
    buffer_store_dword v106, v5, s[12:15], s87 offen sc1
    v_mfma_f32_16x16x32_bf16 v[100:103], v[20:23], v[148:151], v[100:103]
    s_waitcnt lgkmcnt(1)
    v_mfma_f32_16x16x32_bf16 v[108:111], v[12:15], v[144:147], v[108:111]
    ds_read_b128 v[20:23], v2 offset:55296
    v_mfma_f32_16x16x32_bf16 v[36:39], v[12:15], v[148:151], v[36:39]
    s_waitcnt lgkmcnt(1)
    v_mfma_f32_16x16x32_bf16 v[92:95], v[16:19], v[152:155], v[92:95]
    ds_read_b128 v[12:15], v1 offset:57344
    buffer_store_dword v107, v6, s[12:15], s87 offen sc1
    v_mfma_f32_16x16x32_bf16 v[100:103], v[16:19], v[156:159], v[100:103]
    s_waitcnt lgkmcnt(1)
    v_mfma_f32_16x16x32_bf16 v[108:111], v[20:23], v[152:155], v[108:111]
    ds_read_b128 v[16:19], v1 offset:59392
    v_mfma_f32_16x16x32_bf16 v[36:39], v[20:23], v[156:159], v[36:39]
    s_waitcnt lgkmcnt(1)
    v_mfma_f32_16x16x32_bf16 v[92:95], v[12:15], v[160:163], v[92:95]
    ds_read_b128 v[20:23], v2 offset:57344
    buffer_store_dword v32, v0, s[12:15], s88 offen sc1
    v_mfma_f32_16x16x32_bf16 v[100:103], v[12:15], v[164:167], v[100:103]
    s_waitcnt lgkmcnt(1)
    v_mfma_f32_16x16x32_bf16 v[108:111], v[16:19], v[160:163], v[108:111]
    ds_read_b128 v[12:15], v2 offset:59392
    v_mfma_f32_16x16x32_bf16 v[36:39], v[16:19], v[164:167], v[36:39]
    s_waitcnt lgkmcnt(1)
    v_mfma_f32_16x16x32_bf16 v[92:95], v[20:23], v[168:171], v[92:95]
    ds_read_b128 v[16:19], v1 offset:61440
    buffer_store_dword v33, v4, s[12:15], s88 offen sc1
    v_mfma_f32_16x16x32_bf16 v[100:103], v[20:23], v[172:175], v[100:103]
    s_waitcnt lgkmcnt(1)
    v_mfma_f32_16x16x32_bf16 v[108:111], v[12:15], v[168:171], v[108:111]
    ds_read_b128 v[20:23], v1 offset:63488
    v_mfma_f32_16x16x32_bf16 v[36:39], v[12:15], v[172:175], v[36:39]
    s_waitcnt lgkmcnt(1)
    v_mfma_f32_16x16x32_bf16 v[92:95], v[16:19], v[176:179], v[92:95]
    ds_read_b128 v[12:15], v2 offset:61440
    buffer_store_dword v34, v5, s[12:15], s88 offen sc1
    v_mfma_f32_16x16x32_bf16 v[100:103], v[16:19], v[180:183], v[100:103]
    s_waitcnt lgkmcnt(1)
    v_mfma_f32_16x16x32_bf16 v[108:111], v[20:23], v[176:179], v[108:111]
    ds_read_b128 v[16:19], v2 offset:63488
    v_mfma_f32_16x16x32_bf16 v[36:39], v[20:23], v[180:183], v[36:39]
    s_waitcnt lgkmcnt(1)
    v_mfma_f32_16x16x32_bf16 v[92:95], v[12:15], v[184:187], v[92:95]
    v_add_u32 v1, s59, v1
    v_add_u32 v2, s59, v2
    ds_read_b128 v[20:23], v1 offset:0
    buffer_store_dword v35, v6, s[12:15], s88 offen sc1
    v_mfma_f32_16x16x32_bf16 v[100:103], v[12:15], v[188:191], v[100:103]
    s_waitcnt lgkmcnt(1)
    v_mfma_f32_16x16x32_bf16 v[108:111], v[16:19], v[184:187], v[108:111]
    ds_read_b128 v[12:15], v1 offset:2048
    v_mfma_f32_16x16x32_bf16 v[36:39], v[16:19], v[188:191], v[36:39]
    s_waitcnt lgkmcnt(1)
    v_mfma_f32_16x16x32_bf16 v[92:95], v[20:23], v[192:195], v[92:95]
    ds_read_b128 v[16:19], v2 offset:0
    buffer_store_dword v40, v0, s[12:15], s89 offen sc1
    v_mfma_f32_16x16x32_bf16 v[100:103], v[20:23], v[196:199], v[100:103]
    s_waitcnt lgkmcnt(1)
    v_mfma_f32_16x16x32_bf16 v[108:111], v[12:15], v[192:195], v[108:111]
    ds_read_b128 v[20:23], v2 offset:2048
    v_mfma_f32_16x16x32_bf16 v[36:39], v[12:15], v[196:199], v[36:39]
    s_waitcnt lgkmcnt(1)
    v_mfma_f32_16x16x32_bf16 v[92:95], v[16:19], v[200:203], v[92:95]
    ds_read_b128 v[12:15], v1 offset:4096
    buffer_store_dword v41, v4, s[12:15], s89 offen sc1
    v_mfma_f32_16x16x32_bf16 v[100:103], v[16:19], v[204:207], v[100:103]
    s_waitcnt lgkmcnt(1)
    v_mfma_f32_16x16x32_bf16 v[108:111], v[20:23], v[200:203], v[108:111]
    ds_read_b128 v[16:19], v1 offset:6144
    v_mfma_f32_16x16x32_bf16 v[36:39], v[20:23], v[204:207], v[36:39]
    s_waitcnt lgkmcnt(1)
    v_mfma_f32_16x16x32_bf16 v[92:95], v[12:15], v[208:211], v[92:95]
    ds_read_b128 v[20:23], v2 offset:4096
    buffer_store_dword v42, v5, s[12:15], s89 offen sc1
    v_mfma_f32_16x16x32_bf16 v[100:103], v[12:15], v[212:215], v[100:103]
    s_waitcnt lgkmcnt(1)
    v_mfma_f32_16x16x32_bf16 v[108:111], v[16:19], v[208:211], v[108:111]
    ds_read_b128 v[12:15], v2 offset:6144
    v_mfma_f32_16x16x32_bf16 v[36:39], v[16:19], v[212:215], v[36:39]
    s_waitcnt lgkmcnt(1)
    v_mfma_f32_16x16x32_bf16 v[92:95], v[20:23], v[216:219], v[92:95]
    ds_read_b128 v[16:19], v1 offset:8192
    buffer_store_dword v43, v6, s[12:15], s89 offen sc1
    v_mfma_f32_16x16x32_bf16 v[100:103], v[20:23], v[220:223], v[100:103]
    s_waitcnt lgkmcnt(1)
    v_mfma_f32_16x16x32_bf16 v[108:111], v[12:15], v[216:219], v[108:111]
    ds_read_b128 v[20:23], v1 offset:10240
    v_mfma_f32_16x16x32_bf16 v[36:39], v[12:15], v[220:223], v[36:39]
    s_waitcnt lgkmcnt(1)
    v_mfma_f32_16x16x32_bf16 v[92:95], v[16:19], v[224:227], v[92:95]
    ds_read_b128 v[12:15], v2 offset:8192
    buffer_store_dword v24, v0, s[12:15], s90 offen sc1
    v_mfma_f32_16x16x32_bf16 v[100:103], v[16:19], v[228:231], v[100:103]
    s_waitcnt lgkmcnt(1)
    v_mfma_f32_16x16x32_bf16 v[108:111], v[20:23], v[224:227], v[108:111]
    ds_read_b128 v[16:19], v2 offset:10240
L_t21:
    s_cbranch_vccnz L_tret
    v_mfma_f32_16x16x32_bf16 v[36:39], v[20:23], v[228:231], v[36:39]
    s_waitcnt lgkmcnt(1)
    v_mfma_f32_16x16x32_bf16 v[92:95], v[12:15], v[232:235], v[92:95]
    ds_read_b128 v[20:23], v1 offset:12288
    buffer_store_dword v25, v4, s[12:15], s90 offen sc1
    v_mfma_f32_16x16x32_bf16 v[100:103], v[12:15], v[236:239], v[100:103]
    s_waitcnt lgkmcnt(1)
    v_mfma_f32_16x16x32_bf16 v[108:111], v[16:19], v[232:235], v[108:111]
    ds_read_b128 v[12:15], v1 offset:14336
    v_mfma_f32_16x16x32_bf16 v[36:39], v[16:19], v[236:239], v[36:39]
    s_waitcnt lgkmcnt(1)
    v_mfma_f32_16x16x32_bf16 v[92:95], v[20:23], v[240:243], v[92:95]
    ds_read_b128 v[16:19], v2 offset:12288
    buffer_store_dword v26, v5, s[12:15], s90 offen sc1
    v_mfma_f32_16x16x32_bf16 v[100:103], v[20:23], v[244:247], v[100:103]
    s_waitcnt lgkmcnt(1)
    v_mfma_f32_16x16x32_bf16 v[108:111], v[12:15], v[240:243], v[108:111]
    ds_read_b128 v[20:23], v2 offset:14336
    v_mfma_f32_16x16x32_bf16 v[36:39], v[12:15], v[244:247], v[36:39]
    s_waitcnt lgkmcnt(1)
    v_mfma_f32_16x16x32_bf16 v[92:95], v[16:19], v[248:251], v[92:95]
    s_barrier
    v_add_u32 v1, s64, v1
    v_add_u32 v2, s64, v2
    ds_read_b128 v[12:15], v1 offset:0
    buffer_store_dword v27, v6, s[12:15], s90 offen sc1
    v_mfma_f32_16x16x32_bf16 v[100:103], v[16:19], v[252:255], v[100:103]
    s_waitcnt lgkmcnt(1)
    v_mfma_f32_16x16x32_bf16 v[108:111], v[20:23], v[248:251], v[108:111]
    ds_read_b128 v[16:19], v1 offset:2048
    v_mfma_f32_16x16x32_bf16 v[36:39], v[20:23], v[252:255], v[36:39]
    s_waitcnt lgkmcnt(1)
    v_mfma_f32_16x16x32_bf16 v[44:47], v[12:15], v[112:115], 0
    ds_read_b128 v[20:23], v2 offset:0
    buffer_store_dword v8, v0, s[12:15], s91 offen sc1
    v_mfma_f32_16x16x32_bf16 v[48:51], v[12:15], v[116:119], 0
    v_cvt_pk_bf16_f32 v92, v92, v100
    s_waitcnt lgkmcnt(1)
    v_mfma_f32_16x16x32_bf16 v[56:59], v[16:19], v[112:115], 0
    ds_read_b128 v[12:15], v2 offset:2048
    v_cvt_pk_bf16_f32 v93, v93, v101
    v_mfma_f32_16x16x32_bf16 v[64:67], v[16:19], v[116:119], 0
    v_cvt_pk_bf16_f32 v94, v94, v102
    s_waitcnt lgkmcnt(1)
    v_mfma_f32_16x16x32_bf16 v[44:47], v[20:23], v[120:123], v[44:47]
    ds_read_b128 v[16:19], v1 offset:4096
    buffer_store_dword v9, v4, s[12:15], s91 offen sc1
    v_mfma_f32_16x16x32_bf16 v[48:51], v[20:23], v[124:127], v[48:51]
    v_cvt_pk_bf16_f32 v95, v95, v103
    s_waitcnt lgkmcnt(1)
    v_mfma_f32_16x16x32_bf16 v[56:59], v[12:15], v[120:123], v[56:59]
    ds_read_b128 v[20:23], v1 offset:6144
    v_cvt_pk_bf16_f32 v108, v108, v36
    v_mfma_f32_16x16x32_bf16 v[64:67], v[12:15], v[124:127], v[64:67]
    v_cvt_pk_bf16_f32 v109, v109, v37
    s_waitcnt lgkmcnt(1)
    v_mfma_f32_16x16x32_bf16 v[44:47], v[16:19], v[128:131], v[44:47]
    ds_read_b128 v[12:15], v2 offset:4096
    buffer_store_dword v10, v5, s[12:15], s91 offen sc1
    v_mfma_f32_16x16x32_bf16 v[48:51], v[16:19], v[132:135], v[48:51]
    v_cvt_pk_bf16_f32 v110, v110, v38
    s_waitcnt lgkmcnt(1)
    v_mfma_f32_16x16x32_bf16 v[56:59], v[20:23], v[128:131], v[56:59]
    ds_read_b128 v[16:19], v2 offset:6144
    v_cvt_pk_bf16_f32 v111, v111, v39
    v_mfma_f32_16x16x32_bf16 v[64:67], v[20:23], v[132:135], v[64:67]
    s_waitcnt lgkmcnt(1)
    v_mfma_f32_16x16x32_bf16 v[44:47], v[12:15], v[136:139], v[44:47]
    ds_read_b128 v[20:23], v1 offset:8192
    buffer_store_dword v11, v6, s[12:15], s91 offen sc1
    v_mfma_f32_16x16x32_bf16 v[48:51], v[12:15], v[140:143], v[48:51]
    s_waitcnt lgkmcnt(1)
    v_mfma_f32_16x16x32_bf16 v[56:59], v[16:19], v[136:139], v[56:59]
    ds_read_b128 v[12:15], v1 offset:10240
    v_mfma_f32_16x16x32_bf16 v[64:67], v[16:19], v[140:143], v[64:67]
    s_waitcnt lgkmcnt(1)
    v_mfma_f32_16x16x32_bf16 v[44:47], v[20:23], v[144:147], v[44:47]
    ds_read_b128 v[16:19], v2 offset:8192
    buffer_store_dword v60, v0, s[12:15], s92 offen sc1
    v_mfma_f32_16x16x32_bf16 v[48:51], v[20:23], v[148:151], v[48:51]
    s_waitcnt lgkmcnt(1)
    v_mfma_f32_16x16x32_bf16 v[56:59], v[12:15], v[144:147], v[56:59]
    ds_read_b128 v[20:23], v2 offset:10240
    v_mfma_f32_16x16x32_bf16 v[64:67], v[12:15], v[148:151], v[64:67]
    s_waitcnt lgkmcnt(1)
    v_mfma_f32_16x16x32_bf16 v[44:47], v[16:19], v[152:155], v[44:47]
    ds_read_b128 v[12:15], v1 offset:12288
    buffer_store_dword v61, v4, s[12:15], s92 offen sc1
    v_mfma_f32_16x16x32_bf16 v[48:51], v[16:19], v[156:159], v[48:51]
    s_waitcnt lgkmcnt(1)
    v_mfma_f32_16x16x32_bf16 v[56:59], v[20:23], v[152:155], v[56:59]
    ds_read_b128 v[16:19], v1 offset:14336
    v_mfma_f32_16x16x32_bf16 v[64:67], v[20:23], v[156:159], v[64:67]
    s_waitcnt lgkmcnt(1)
    v_mfma_f32_16x16x32_bf16 v[44:47], v[12:15], v[160:163], v[44:47]
    ds_read_b128 v[20:23], v2 offset:12288
    buffer_store_dword v62, v5, s[12:15], s92 offen sc1
    v_mfma_f32_16x16x32_bf16 v[48:51], v[12:15], v[164:167], v[48:51]
    s_waitcnt lgkmcnt(1)
    v_mfma_f32_16x16x32_bf16 v[56:59], v[16:19], v[160:163], v[56:59]
    ds_read_b128 v[12:15], v2 offset:14336
    v_mfma_f32_16x16x32_bf16 v[64:67], v[16:19], v[164:167], v[64:67]
    s_waitcnt lgkmcnt(1)
    v_mfma_f32_16x16x32_bf16 v[44:47], v[20:23], v[168:171], v[44:47]
    ds_read_b128 v[16:19], v1 offset:16384
    buffer_store_dword v63, v6, s[12:15], s92 offen sc1
    v_mfma_f32_16x16x32_bf16 v[48:51], v[20:23], v[172:175], v[48:51]
    s_waitcnt lgkmcnt(1)
    v_mfma_f32_16x16x32_bf16 v[56:59], v[12:15], v[168:171], v[56:59]
    ds_read_b128 v[20:23], v1 offset:18432
    v_mfma_f32_16x16x32_bf16 v[64:67], v[12:15], v[172:175], v[64:67]
    s_waitcnt lgkmcnt(1)
    v_mfma_f32_16x16x32_bf16 v[44:47], v[16:19], v[176:179], v[44:47]
    ds_read_b128 v[12:15], v2 offset:16384
    buffer_store_dword v76, v0, s[12:15], s93 offen sc1
    v_mfma_f32_16x16x32_bf16 v[48:51], v[16:19], v[180:183], v[48:51]
    s_waitcnt lgkmcnt(1)
    v_mfma_f32_16x16x32_bf16 v[56:59], v[20:23], v[176:179], v[56:59]
    ds_read_b128 v[16:19], v2 offset:18432
    v_mfma_f32_16x16x32_bf16 v[64:67], v[20:23], v[180:183], v[64:67]
    s_waitcnt lgkmcnt(1)
    v_mfma_f32_16x16x32_bf16 v[44:47], v[12:15], v[184:187], v[44:47]
    ds_read_b128 v[20:23], v1 offset:20480
    buffer_store_dword v77, v4, s[12:15], s93 offen sc1
    v_mfma_f32_16x16x32_bf16 v[48:51], v[12:15], v[188:191], v[48:51]
    s_waitcnt lgkmcnt(1)
    v_mfma_f32_16x16x32_bf16 v[56:59], v[16:19], v[184:187], v[56:59]
    ds_read_b128 v[12:15], v1 offset:22528
    v_mfma_f32_16x16x32_bf16 v[64:67], v[16:19], v[188:191], v[64:67]
    s_waitcnt lgkmcnt(1)
    v_mfma_f32_16x16x32_bf16 v[44:47], v[20:23], v[192:195], v[44:47]
    ds_read_b128 v[16:19], v2 offset:20480
    buffer_store_dword v78, v5, s[12:15], s93 offen sc1
    v_mfma_f32_16x16x32_bf16 v[48:51], v[20:23], v[196:199], v[48:51]
    s_waitcnt lgkmcnt(1)
    v_mfma_f32_16x16x32_bf16 v[56:59], v[12:15], v[192:195], v[56:59]
    ds_read_b128 v[20:23], v2 offset:22528
    v_mfma_f32_16x16x32_bf16 v[64:67], v[12:15], v[196:199], v[64:67]
    s_waitcnt lgkmcnt(1)
    v_mfma_f32_16x16x32_bf16 v[44:47], v[16:19], v[200:203], v[44:47]
    ds_read_b128 v[12:15], v1 offset:24576
    buffer_store_dword v79, v6, s[12:15], s93 offen sc1
    v_mfma_f32_16x16x32_bf16 v[48:51], v[16:19], v[204:207], v[48:51]
L_t22:
    s_cbranch_vccnz L_tret
    s_waitcnt lgkmcnt(1)
    v_mfma_f32_16x16x32_bf16 v[56:59], v[20:23], v[200:203], v[56:59]
    ds_read_b128 v[16:19], v1 offset:26624
    v_mfma_f32_16x16x32_bf16 v[64:67], v[20:23], v[204:207], v[64:67]
    s_waitcnt lgkmcnt(1)
    v_mfma_f32_16x16x32_bf16 v[44:47], v[12:15], v[208:211], v[44:47]
    ds_read_b128 v[20:23], v2 offset:24576
    buffer_store_dword v92, v0, s[12:15], s94 offen sc1
    v_mfma_f32_16x16x32_bf16 v[48:51], v[12:15], v[212:215], v[48:51]
    s_waitcnt lgkmcnt(1)
    v_mfma_f32_16x16x32_bf16 v[56:59], v[16:19], v[208:211], v[56:59]
    ds_read_b128 v[12:15], v2 offset:26624
    v_mfma_f32_16x16x32_bf16 v[64:67], v[16:19], v[212:215], v[64:67]
    s_waitcnt lgkmcnt(1)
    v_mfma_f32_16x16x32_bf16 v[44:47], v[20:23], v[216:219], v[44:47]
    ds_read_b128 v[16:19], v1 offset:28672
    buffer_store_dword v93, v4, s[12:15], s94 offen sc1
    v_mfma_f32_16x16x32_bf16 v[48:51], v[20:23], v[220:223], v[48:51]
    s_waitcnt lgkmcnt(1)
    v_mfma_f32_16x16x32_bf16 v[56:59], v[12:15], v[216:219], v[56:59]
    ds_read_b128 v[20:23], v1 offset:30720
    v_mfma_f32_16x16x32_bf16 v[64:67], v[12:15], v[220:223], v[64:67]
    s_waitcnt lgkmcnt(1)
    v_mfma_f32_16x16x32_bf16 v[44:47], v[16:19], v[224:227], v[44:47]
    ds_read_b128 v[12:15], v2 offset:28672
    buffer_store_dword v94, v5, s[12:15], s94 offen sc1
    v_mfma_f32_16x16x32_bf16 v[48:51], v[16:19], v[228:231], v[48:51]
    s_waitcnt lgkmcnt(1)
    v_mfma_f32_16x16x32_bf16 v[56:59], v[20:23], v[224:227], v[56:59]
    ds_read_b128 v[16:19], v2 offset:30720
    v_mfma_f32_16x16x32_bf16 v[64:67], v[20:23], v[228:231], v[64:67]
    s_waitcnt lgkmcnt(1)
    v_mfma_f32_16x16x32_bf16 v[44:47], v[12:15], v[232:235], v[44:47]
    ds_read_b128 v[20:23], v1 offset:32768
    buffer_store_dword v95, v6, s[12:15], s94 offen sc1
    v_mfma_f32_16x16x32_bf16 v[48:51], v[12:15], v[236:239], v[48:51]
    s_waitcnt lgkmcnt(1)
    v_mfma_f32_16x16x32_bf16 v[56:59], v[16:19], v[232:235], v[56:59]
    ds_read_b128 v[12:15], v1 offset:34816
    v_mfma_f32_16x16x32_bf16 v[64:67], v[16:19], v[236:239], v[64:67]
    s_waitcnt lgkmcnt(1)
    v_mfma_f32_16x16x32_bf16 v[44:47], v[20:23], v[240:243], v[44:47]
    ds_read_b128 v[16:19], v2 offset:32768
    buffer_store_dword v108, v0, s[12:15], s95 offen sc1
    v_mfma_f32_16x16x32_bf16 v[48:51], v[20:23], v[244:247], v[48:51]
    s_waitcnt lgkmcnt(1)
    v_mfma_f32_16x16x32_bf16 v[56:59], v[12:15], v[240:243], v[56:59]
    ds_read_b128 v[20:23], v2 offset:34816
    v_mfma_f32_16x16x32_bf16 v[64:67], v[12:15], v[244:247], v[64:67]
    s_waitcnt lgkmcnt(1)
    v_mfma_f32_16x16x32_bf16 v[44:47], v[16:19], v[248:251], v[44:47]
    ds_read_b128 v[12:15], v1 offset:36864
    buffer_store_dword v109, v4, s[12:15], s95 offen sc1
    v_mfma_f32_16x16x32_bf16 v[48:51], v[16:19], v[252:255], v[48:51]
    s_waitcnt lgkmcnt(1)
    v_mfma_f32_16x16x32_bf16 v[56:59], v[20:23], v[248:251], v[56:59]
    ds_read_b128 v[16:19], v2 offset:36864
    v_mfma_f32_16x16x32_bf16 v[64:67], v[20:23], v[252:255], v[64:67]
    s_waitcnt lgkmcnt(1)
    s_cmp_eq_u32 s99, 0
    s_cbranch_scc1 L_c18
    v_mfma_f32_16x16x32_bf16 v[28:31], v[12:15], v[112:115], 0
    ds_read_b128 v[20:23], v1 offset:40960
    buffer_store_dword v110, v5, s[12:15], s95 offen sc1
    v_mfma_f32_16x16x32_bf16 v[52:55], v[12:15], v[116:119], 0
    v_cvt_pk_bf16_f32 v44, v44, v48
    s_waitcnt lgkmcnt(1)
    v_mfma_f32_16x16x32_bf16 v[28:31], v[16:19], v[120:123], v[28:31]
    ds_read_b128 v[12:15], v2 offset:40960
    v_cvt_pk_bf16_f32 v45, v45, v49
    v_mfma_f32_16x16x32_bf16 v[52:55], v[16:19], v[124:127], v[52:55]
    v_cvt_pk_bf16_f32 v46, v46, v50
    s_waitcnt lgkmcnt(1)
    v_mfma_f32_16x16x32_bf16 v[28:31], v[20:23], v[128:131], v[28:31]
    ds_read_b128 v[16:19], v1 offset:45056
    buffer_store_dword v111, v6, s[12:15], s95 offen sc1
    v_mfma_f32_16x16x32_bf16 v[52:55], v[20:23], v[132:135], v[52:55]
    v_cvt_pk_bf16_f32 v47, v47, v51
    s_waitcnt lgkmcnt(1)
    v_mfma_f32_16x16x32_bf16 v[28:31], v[12:15], v[136:139], v[28:31]
    ds_read_b128 v[20:23], v2 offset:45056
    v_cvt_pk_bf16_f32 v56, v56, v64
    v_mfma_f32_16x16x32_bf16 v[52:55], v[12:15], v[140:143], v[52:55]
    v_cvt_pk_bf16_f32 v57, v57, v65
    s_waitcnt lgkmcnt(1)
    v_mfma_f32_16x16x32_bf16 v[28:31], v[16:19], v[144:147], v[28:31]
    ds_read_b128 v[12:15], v1 offset:49152
    buffer_store_dword v44, v0, s[12:15], s96 offen sc1
    v_mfma_f32_16x16x32_bf16 v[52:55], v[16:19], v[148:151], v[52:55]
    v_cvt_pk_bf16_f32 v58, v58, v66
    s_waitcnt lgkmcnt(1)
    v_mfma_f32_16x16x32_bf16 v[28:31], v[20:23], v[152:155], v[28:31]
    ds_read_b128 v[16:19], v2 offset:49152
    v_cvt_pk_bf16_f32 v59, v59, v67
    v_mfma_f32_16x16x32_bf16 v[52:55], v[20:23], v[156:159], v[52:55]
    s_waitcnt lgkmcnt(1)
    v_mfma_f32_16x16x32_bf16 v[28:31], v[12:15], v[160:163], v[28:31]
    ds_read_b128 v[20:23], v1 offset:53248
    buffer_store_dword v45, v4, s[12:15], s96 offen sc1
    v_mfma_f32_16x16x32_bf16 v[52:55], v[12:15], v[164:167], v[52:55]
    s_waitcnt lgkmcnt(1)
    v_mfma_f32_16x16x32_bf16 v[28:31], v[16:19], v[168:171], v[28:31]
    ds_read_b128 v[12:15], v2 offset:53248
    v_mfma_f32_16x16x32_bf16 v[52:55], v[16:19], v[172:175], v[52:55]
    s_waitcnt lgkmcnt(1)
    v_mfma_f32_16x16x32_bf16 v[28:31], v[20:23], v[176:179], v[28:31]
    ds_read_b128 v[16:19], v1 offset:57344
    buffer_store_dword v46, v5, s[12:15], s96 offen sc1
    v_mfma_f32_16x16x32_bf16 v[52:55], v[20:23], v[180:183], v[52:55]
    s_waitcnt lgkmcnt(1)
    v_mfma_f32_16x16x32_bf16 v[28:31], v[12:15], v[184:187], v[28:31]
    ds_read_b128 v[20:23], v2 offset:57344
    v_mfma_f32_16x16x32_bf16 v[52:55], v[12:15], v[188:191], v[52:55]
    s_waitcnt lgkmcnt(1)
    v_mfma_f32_16x16x32_bf16 v[28:31], v[16:19], v[192:195], v[28:31]
    ds_read_b128 v[12:15], v1 offset:61440
    buffer_store_dword v47, v6, s[12:15], s96 offen sc1
    v_mfma_f32_16x16x32_bf16 v[52:55], v[16:19], v[196:199], v[52:55]
    s_waitcnt lgkmcnt(1)
    v_mfma_f32_16x16x32_bf16 v[28:31], v[20:23], v[200:203], v[28:31]
    ds_read_b128 v[16:19], v2 offset:61440
    v_mfma_f32_16x16x32_bf16 v[52:55], v[20:23], v[204:207], v[52:55]
    s_waitcnt lgkmcnt(1)
    v_mfma_f32_16x16x32_bf16 v[28:31], v[12:15], v[208:211], v[28:31]
    v_add_u32 v1, s59, v1
    v_add_u32 v2, s59, v2
    ds_read_b128 v[20:23], v1 offset:0
    buffer_store_dword v56, v0, s[12:15], s97 offen sc1
    v_mfma_f32_16x16x32_bf16 v[52:55], v[12:15], v[212:215], v[52:55]
    s_waitcnt lgkmcnt(1)
    v_mfma_f32_16x16x32_bf16 v[28:31], v[16:19], v[216:219], v[28:31]
    ds_read_b128 v[12:15], v2 offset:0
    v_mfma_f32_16x16x32_bf16 v[52:55], v[16:19], v[220:223], v[52:55]
    s_waitcnt lgkmcnt(1)
    v_mfma_f32_16x16x32_bf16 v[28:31], v[20:23], v[224:227], v[28:31]
    ds_read_b128 v[16:19], v1 offset:4096
    buffer_store_dword v57, v4, s[12:15], s97 offen sc1
    v_mfma_f32_16x16x32_bf16 v[52:55], v[20:23], v[228:231], v[52:55]
    s_waitcnt lgkmcnt(1)
    v_mfma_f32_16x16x32_bf16 v[28:31], v[12:15], v[232:235], v[28:31]
    ds_read_b128 v[20:23], v2 offset:4096
    v_mfma_f32_16x16x32_bf16 v[52:55], v[12:15], v[236:239], v[52:55]
    s_waitcnt lgkmcnt(1)
    v_mfma_f32_16x16x32_bf16 v[28:31], v[16:19], v[240:243], v[28:31]
    buffer_store_dword v58, v5, s[12:15], s97 offen sc1
L_t23:
    s_cbranch_vccnz L_tret
    v_mfma_f32_16x16x32_bf16 v[52:55], v[16:19], v[244:247], v[52:55]
    s_waitcnt lgkmcnt(0)
    v_mfma_f32_16x16x32_bf16 v[28:31], v[20:23], v[248:251], v[28:31]
    v_mfma_f32_16x16x32_bf16 v[52:55], v[20:23], v[252:255], v[52:55]
    buffer_store_dword v59, v6, s[12:15], s97 offen sc1
    s_nop 7
    v_cvt_pk_bf16_f32 v28, v28, v52
    buffer_store_dword v28, v0, s[12:15], s98 offen sc1
    v_cvt_pk_bf16_f32 v29, v29, v53
    buffer_store_dword v29, v4, s[12:15], s98 offen sc1
    v_cvt_pk_bf16_f32 v30, v30, v54
    buffer_store_dword v30, v5, s[12:15], s98 offen sc1
    v_cvt_pk_bf16_f32 v31, v31, v55
    buffer_store_dword v31, v6, s[12:15], s98 offen sc1
    s_endpgm
L_c18:
    s_cbranch_vccnz L_tret
    buffer_store_dword v110, v5, s[12:15], s95 offen sc1
    buffer_store_dword v111, v6, s[12:15], s95 offen sc1
    v_cvt_pk_bf16_f32 v44, v44, v48
    buffer_store_dword v44, v0, s[12:15], s96 offen sc1
    v_cvt_pk_bf16_f32 v45, v45, v49
    buffer_store_dword v45, v4, s[12:15], s96 offen sc1
    v_cvt_pk_bf16_f32 v46, v46, v50
    buffer_store_dword v46, v5, s[12:15], s96 offen sc1
    v_cvt_pk_bf16_f32 v47, v47, v51
    buffer_store_dword v47, v6, s[12:15], s96 offen sc1
    v_cvt_pk_bf16_f32 v56, v56, v64
    buffer_store_dword v56, v0, s[12:15], s97 offen sc1
    v_cvt_pk_bf16_f32 v57, v57, v65
    buffer_store_dword v57, v4, s[12:15], s97 offen sc1
    v_cvt_pk_bf16_f32 v58, v58, v66
    buffer_store_dword v58, v5, s[12:15], s97 offen sc1
    v_cvt_pk_bf16_f32 v59, v59, v67
    buffer_store_dword v59, v6, s[12:15], s97 offen sc1
    s_endpgm
.if (L_ttab - L_tpc) != 28
.error "touch table offset"
.endif
.section .rodata,"a"
.p2align 6
.amdhsa_kernel standalone__normalfloat_lut_nf4__prompt_kernel
  .amdhsa_next_free_vgpr 256
  .amdhsa_next_free_sgpr 100
  .amdhsa_accum_offset 256
  .amdhsa_group_segment_fixed_size 0
  .amdhsa_kernarg_size 48
  .amdhsa_user_sgpr_count 2
  .amdhsa_user_sgpr_kernarg_segment_ptr 1
  .amdhsa_system_sgpr_workgroup_id_x 1
  .amdhsa_float_denorm_mode_32 3
.end_amdhsa_kernel
```
